```python
import torch

def _softmax(x, axis=-1):
    return torch.softmax(x, dim=axis)
def _gelu(x):
    return torch.nn.functional.gelu(x, approximate="tanh")
def _silu(x):
    return torch.nn.functional.silu(x)
def _sigmoid(x):
    return torch.sigmoid(x)
def _layernorm(x, axis=-1, eps=1e-5):
    m = x.mean(dim=axis, keepdim=True)
    v = x.var(dim=axis, keepdim=True, unbiased=False)
    return (x - m) / torch.sqrt(v + eps)
def _scatter_add(tgt, idx, src, axis=0):
    return tgt.clone().index_add_(axis, idx, src)
def _segment_sum(src, seg, n):
    out = torch.zeros((n,) + src.shape[1:], dtype=src.dtype)
    return out.index_add_(0, seg, src)
def _pad(x, pw):
    flat = tuple(v for pair in reversed(pw) for v in pair)
    return torch.nn.functional.pad(x, flat)

kernel_name = 'sequential_preLN__spectral_gfnet__glu_gated_glu__prompt'

def setup_inputs():

    _w = (lambda a: (lambda t: t.to(torch.bfloat16) if t.is_floating_point() else t)(torch.as_tensor(a)))
    def _A_setup():
        B, S, D = 1, 2048, 512
        Df = D // 2 + 1
        return {
            "x": _w((lambda *s: torch.randn(*s, dtype=torch.bfloat16) * 0.05)(B, S, D)),
            "w_r": _w((lambda *s: torch.randn(*s, dtype=torch.bfloat16) * 0.4)(S, Df) * 0.02),
            "w_i": _w((lambda *s: torch.randn(*s, dtype=torch.bfloat16) * 0.4)(S, Df) * 0.02),
        }
    _A_in = _A_setup()

    def _B_setup():
        B, S, D, F = 1, 2048, 512, 1792
        return {
            "x": _w((lambda *s: torch.randn(*s, dtype=torch.bfloat16) * 0.05)(B, S, D)),
            "w_gate": _w((lambda *s: torch.randn(*s, dtype=torch.bfloat16) * 0.05)(D, F)),
            "w_up": _w((lambda *s: torch.randn(*s, dtype=torch.bfloat16) * 0.05)(D, F)),
            "w_down": _w((lambda *s: torch.randn(*s, dtype=torch.bfloat16) * 0.05)(F, D)),
        }
    _B_in = _B_setup()

    return {
        "A_x": _A_in["x"],
        "A_w_r": _A_in["w_r"],
        "A_w_i": _A_in["w_i"],
        "B_x": _B_in["x"],
        "B_w_gate": _B_in["w_gate"],
        "B_w_up": _B_in["w_up"],
        "B_w_down": _B_in["w_down"],
    }

def reference(A_x, A_w_r, A_w_i, B_x, B_w_gate, B_w_up, B_w_down):
    def _A_ref(x, w_r, w_i):
        B, S, D = x.shape
        X = (lambda x, axes=(-2,-1): torch.fft.rfft2(x.float(), dim=axes))(x, axes=(-2, -1))
        W = w_r + 1j * w_i
        X = X * W
        y = (lambda x, s, axes=(-2,-1): torch.fft.irfft2(x, s=s, dim=axes).to(torch.bfloat16))(X, (S, D), axes=(-2, -1))
        return y

    def _B_ref(x, w_gate, w_up, w_down):
        g = torch.einsum("bsd,df->bsf", x, w_gate)
        u = torch.einsum("bsd,df->bsf", x, w_up)
        h = _sigmoid(g) * u
        return torch.einsum("bsf,fd->bsd", h, w_down)

    x = A_x
    h = x + _A_ref(_layernorm(x, axis=-1), A_w_r, A_w_i)
    h2 = h + _B_ref(_layernorm(h, axis=-1), B_w_gate, B_w_up, B_w_down)
    return h2
```

```asm
; @launch grid=(256,1,1) block=(256,1,1) lds=163840
.amdgcn_target "amdgcn-amd-amdhsa--gfx950"
.text
.globl sequential_preLN__spectral_gfnet__glu_gated_glu__prompt_kernel
.p2align 8
.type sequential_preLN__spectral_gfnet__glu_gated_glu__prompt_kernel,@function
sequential_preLN__spectral_gfnet__glu_gated_glu__prompt_kernel:
    s_cmp_ge_u32 s2, 256
    s_cbranch_scc1 p_done
    s_load_dwordx16 s[36:51], s[0:1], 0
    s_load_dwordx4 s[52:55], s[0:1], 64
    s_getpc_b64 s[8:9]
p_pc:
    v_lshlrev_b32 v1, 6, v0
    s_and_b32 s9, s9, 0xffff
    s_mov_b32 s10, p_done-p_pc
    s_mov_b32 s11, 0x20000
    s_movk_i32 s3, 0x4000
    buffer_load_dword a255, v1, s[8:11], 0 offen
    buffer_load_dword a254, v1, s[8:11], s3 offen
    s_and_b32 s56, s2, 7
    s_lshl_b32 s56, s56, 5
    s_lshr_b32 s57, s2, 3
    s_add_u32 s56, s56, s57
    v_lshrrev_b32 v3, 6, v0
    v_and_b32 v1, 63, v0
    v_readfirstlane_b32 s3, v3
    v_and_b32 v2, 15, v0
    v_lshrrev_b32 v3, 4, v1
    v_lshlrev_b32 v4, 4, v1
    v_lshrrev_b32 v15, 1, v1
    v_mul_u32_u24 v15, 3584, v15
    v_and_b32 v13, 1, v1
    v_lshl_add_u32 v15, v13, 4, v15
    v_lshlrev_b32 v241, 4, v0
    v_mov_b32 v242, 4096
    v_mov_b32 v243, 0
    s_lshl_b32 s57, s3, 11
    s_lshl_b32 s4, s2, 13
    s_add_u32 s4, s4, s57
    s_mul_i32 s5, s2, 4112
    s_lshl_b32 s6, s3, 10
    s_lshl_b32 s99, s3, 15
    s_add_u32 s99, s99, 32768
    s_sub_u32 s7, s56, 224
    s_lshr_b32 s97, s7, 1
    s_add_u32 s97, s97, 112
    s_and_b32 s7, s7, 1
    s_lshl_b32 s7, s7, 4
    s_cmp_ge_u32 s56, 112
    s_cselect_b32 s96, 112, 0
    s_cselect_b32 s98, 16, 0
    s_sub_u32 s96, s56, s96
    s_cmp_ge_u32 s56, 224
    s_cselect_b32 s59, 0, s96
    s_cselect_b32 s96, s97, s96
    s_cselect_b32 s98, s7, s98
    s_mul_i32 s97, s3, 458752
    s_lshl_b32 s59, s59, 5
    s_add_u32 s97, s97, s59
    s_bfe_u32 s100, s59, 0x20005
    s_lshl_b32 s100, s100, 2
    s_add_u32 s100, s100, s3
    s_mul_i32 s100, s100, 114688
    s_andn2_b32 s101, s59, 127
    s_add_u32 s100, s100, s101
    s_lshl_b32 s59, s2, 2
    s_add_u32 s59, s59, s3
    s_mov_b32 m0, s57
    v_cvt_f32_u32 v88, v2
    v_cvt_f32_u32 v89, v3
    v_mul_f32 v13, 0x3d000000, v88
    v_mul_f32 v89, 4.0, v89
    v_mul_f32 v91, v13, v89
    v_add_f32 v92, v91, v13
    v_add_f32 v93, v92, v13
    v_add_f32 v94, v93, v13
    v_and_b32 v90, 1, v2
    v_mul_u32_u24 v90, 0x8000, v90
    v_lshl_or_b32 v90, v90, 16, v90
    v_cos_f32 v99, v91
    v_sin_f32 v107, v91
    v_cos_f32 v100, v92
    v_sin_f32 v108, v92
    v_cos_f32 v101, v93
    v_sin_f32 v109, v93
    v_cos_f32 v102, v94
    v_sin_f32 v110, v94
    v_cvt_pk_f16_f32 v128, v99, v100
    v_cvt_pk_f16_f32 v129, v101, v102
    v_cvt_pk_f16_f32 v144, -v107, -v108
    v_cvt_pk_f16_f32 v145, -v109, -v110
    v_cvt_pk_f16_f32 v136, v107, v108
    v_cvt_pk_f16_f32 v137, v109, v110
    v_mul_f32 v99, 0x3a000000, v99
    v_mul_f32 v107, 0x3a000000, v107
    v_mul_f32 v100, 0x3a000000, v100
    v_mul_f32 v108, 0x3a000000, v108
    v_mul_f32 v101, 0x3a000000, v101
    v_mul_f32 v109, 0x3a000000, v109
    v_mul_f32 v102, 0x3a000000, v102
    v_mul_f32 v110, 0x3a000000, v110
    v_cvt_pk_bf16_f32 v152, v99, v100
    v_cvt_pk_bf16_f32 v153, v101, v102
    v_cvt_pk_bf16_f32 v168, -v107, -v108
    v_cvt_pk_bf16_f32 v169, -v109, -v110
    v_cvt_pk_bf16_f32 v160, v107, v108
    v_cvt_pk_bf16_f32 v161, v109, v110
    s_waitcnt lgkmcnt(0)
    s_mov_b32 s8, s36
    s_and_b32 s9, s37, 0xffff
    s_mov_b32 s10, 0x200000
    s_mov_b32 s11, 0x20000
    buffer_load_dwordx4 v4, s[8:11], s4 offen  lds
    buffer_load_dwordx4 v4, s[8:11], s4 offen offset:1024  lds
    s_cmp_ge_u32 s56, 112
    s_cselect_b32 s24, s46, s44
    s_cselect_b32 s25, s47, s45
    s_and_b32 s25, s25, 0xffff
    s_mov_b32 s26, 0x1c0000
    s_mov_b32 s27, 0x20000
    s_mov_b32 s16, s38
    s_and_b32 s17, s39, 0xffff
    s_mov_b32 s18, 0x101000
    s_mov_b32 s19, 0x20000
    s_mov_b32 s20, s40
    s_and_b32 s21, s41, 0xffff
    s_mov_b32 s22, 0x101000
    s_mov_b32 s23, 0x20000
    s_add_u32 m0, s6, 16640
    s_nop 0
    buffer_load_dwordx4 v241, s[16:19], s5 offen  lds
    s_add_u32 m0, s6, 20992
    s_nop 0
    buffer_load_dwordx4 v241, s[20:23], s5 offen  lds
    s_mov_b32 m0, 20736
    s_mov_b64 exec, 1
    buffer_load_dwordx4 v242, s[16:19], s5 offen  lds
    s_mov_b64 exec, -1
    s_mov_b32 m0, 25088
    s_mov_b64 exec, 1
    buffer_load_dwordx4 v242, s[20:23], s5 offen  lds
    s_mov_b64 exec, -1
    s_mov_b32 s12, s54
    s_and_b32 s13, s55, 0xffff
    s_mov_b32 s14, 0x13c0000
    s_mov_b32 s15, 0x20000
    v_lshlrev_b32 v11, 8, v1
    s_cmp_eq_u32 s59, 3
    s_cselect_b32 s40, 0, 1
    s_mul_i32 s40, s40, 0x7fac0000
    s_add_u32 s40, s40, 0x440000
    s_add_u32 s41, s40, 16384
    buffer_store_dword v243, v11, s[12:15], s40 offen sc1
    buffer_store_dword v243, v11, s[12:15], s41 offen sc1
    v_mov_b32 v244, -1
    v_mov_b32 v245, -1
    v_mov_b32 v246, -1
    v_mov_b32 v247, -1
    s_mul_i32 s8, s2, 8704
    s_add_u32 s8, s8, s6
    s_add_u32 s8, s8, 0x490000
    s_add_u32 s9, s8, 4352
    v_and_b32 v12, 1, v1
    v_mul_u32_u24 v12, 48, v12
    v_add_u32 v12, v12, v15
    s_mov_b32 s55, s100
    s_mov_b32 s32, s52
    s_and_b32 s33, s53, 0xffff
    s_mov_b32 s34, 0x100
    s_mov_b32 s35, 0x20000
    s_mov_b32 s28, s48
    s_and_b32 s29, s49, 0xffff
    s_mov_b32 s30, 0x1c0000
    s_mov_b32 s31, 0x20000
    s_mov_b32 s36, s50
    s_and_b32 s37, s51, 0xffff
    s_mov_b32 s38, 0x200000
    s_mov_b32 s39, 0x20000
    v_xor_b32 v130, v90, v128
    v_xor_b32 v131, v90, v129
    v_xor_b32 v132, 0x80000000, v128
    v_xor_b32 v133, 0x80000000, v129
    v_xor_b32 v134, 0x80000000, v130
    v_xor_b32 v135, 0x80000000, v131
    v_xor_b32 v146, v90, v144
    v_xor_b32 v147, v90, v145
    v_xor_b32 v148, 0x80000000, v144
    v_xor_b32 v149, 0x80000000, v145
    v_xor_b32 v150, 0x80000000, v146
    v_xor_b32 v151, 0x80000000, v147
    v_cmp_eq_u32 vcc, 0, v2
    v_add_f32 v13, 0x41800000, v88
    v_mov_b32 v14, 0x43800000
    v_cndmask_b32 v14, v88, v14, vcc
    v_mul_f32 v13, 0x3b000000, v13
    v_mul_f32 v14, 0x3b000000, v14
    v_mul_f32 v91, v14, v89
    v_mul_f32 v95, v13, v89
    v_add_f32 v92, v91, v14
    v_add_f32 v96, v95, v13
    v_add_f32 v93, v92, v14
    v_add_f32 v97, v96, v13
    v_add_f32 v94, v93, v14
    buffer_store_dwordx4 v[244:247], v4, s[12:15], s8 offen sc1
    v_add_f32 v98, v97, v13
    v_cos_f32 v16, v91
    v_sin_f32 v24, v91
    v_cos_f32 v17, v92
    v_sin_f32 v25, v92
    v_cos_f32 v18, v93
    v_sin_f32 v26, v93
    v_cos_f32 v19, v94
    v_sin_f32 v27, v94
    v_cos_f32 v20, v95
    v_sin_f32 v28, v95
    v_cos_f32 v21, v96
    v_sin_f32 v29, v96
    v_cos_f32 v22, v97
    v_sin_f32 v30, v97
    v_cos_f32 v23, v98
    v_sin_f32 v31, v98
    v_mov_b32 v13, -1.0
    v_cndmask_b32 v37, 1.0, v13, vcc
    v_cndmask_b32 v39, 1.0, v13, vcc
    v_mov_b32 v38, 1.0
    v_cmp_eq_u32 vcc, 0, v1
    v_mov_b32 v13, 0x3f3504f3
    v_lshrrev_b32 v14, 1, v2
    v_cndmask_b32 v36, 1.0, v13, vcc
    buffer_store_dwordx4 v[244:247], v4, s[12:15], s9 offen sc1
    v_and_b32 v13, 1, v2
    v_cvt_f32_u32 v14, v14
    v_cvt_f32_u32 v13, v13
    v_mul_f32 v14, 0x3d800000, v14
    v_mul_f32 v13, 0x3e800000, v13
    v_fma_f32 v91, v14, v89, v13
    v_add_f32 v92, v91, v14
    v_add_f32 v93, v92, v14
    v_add_f32 v94, v93, v14
    v_sin_f32 v95, v91
    v_cos_f32 v91, v91
    v_sin_f32 v96, v92
    v_cos_f32 v92, v92
    v_sin_f32 v97, v93
    v_cos_f32 v93, v93
    v_sin_f32 v98, v94
    v_cos_f32 v94, v94
    v_cvt_pk_f16_f32 v32, v91, v92
    v_cvt_pk_f16_f32 v33, v93, v94
    v_cvt_pk_f16_f32 v34, v95, v96
    v_cvt_pk_f16_f32 v35, v97, v98
    v_lshl_add_u32 v40, v1, 3, s57
    v_lshl_add_u32 v41, v1, 5, s57
    v_bfe_u32 v13, v1, 2, 2
    v_lshl_add_u32 v46, v13, 9, s99
    buffer_load_dword a253, v12, s[24:27], s55 offen
    v_lshl_add_u32 v46, v3, 5, v46
    v_and_b32 v13, 3, v1
    v_lshl_add_u32 v46, v13, 3, v46
    v_mul_u32_u24 v45, 1040, v13
    v_lshrrev_b32 v13, 3, v2
    v_bfe_u32 v14, v2, 2, 1
    v_lshl_add_u32 v13, v14, 1, v13
    v_mul_u32_u24 v13, 32832, v13
    v_add_u32 v45, v45, v13
    v_lshl_add_u32 v45, v3, 4, v45
    s_and_b32 s43, s3, 1
    s_lshl_b32 s43, s43, 9
    s_lshr_b32 s44, s3, 1
    s_lshl_b32 s44, s44, 3
    s_add_u32 s43, s43, s44
    v_add_u32 v45, s43, v45
    s_lshl_b32 s43, s3, 6
    s_add_u32 s43, s43, s99
    v_add_u32 v47, s43, v4
    v_bfe_u32 v42, v0, 2, 4
    v_bfe_u32 v13, v0, 1, 1
    v_lshl_add_u32 v42, v13, 4, v42
    v_and_b32 v13, 1, v0
    v_lshl_add_u32 v13, s3, 1, v13
    v_lshlrev_b32 v13, 5, v13
    v_cmp_eq_u32 vcc, 0, v42
    v_add_u32 v42, v42, v13
    v_sub_u32 v13, 0x100, v13
    v_cndmask_b32 v42, v42, v13, vcc
    v_lshlrev_b32 v42, 1, v42
    s_and_b32 s4, s2, 1
    s_lshl_b32 s4, s4, 3
    s_bfe_u32 s5, s2, 0x30003
    s_add_u32 s4, s4, s5
    s_bfe_u32 s5, s2, 0x20001
    s_lshl_b32 s5, s5, 2
    s_lshr_b32 s6, s2, 6
    s_add_u32 s5, s5, s6
    s_and_b32 s6, s2, 7
    s_lshl_b32 s6, s6, 2
    s_bfe_u32 s7, s2, 0x20003
    s_add_u32 s6, s6, s7
    s_lshr_b32 s7, s2, 5
    s_lshl_b32 s43, s4, 4
    s_add_u32 s43, s43, s5
    s_lshl_b32 s43, s43, 2
    s_add_u32 s43, s43, s3
    s_lshl_b32 s100, s43, 7
    s_add_u32 s100, s100, 0x420000
    s_lshl_b32 s101, s2, 8
    s_lshl_b32 s42, s3, 16
    s_add_u32 s101, s101, s42
    s_add_u32 s101, s101, 0x450000
    s_and_b32 s42, s2, 15
    s_lshl_b32 s42, s42, 8
    s_add_u32 s42, s42, 0x440000
    s_cmp_eq_u32 s3, 0
    s_cselect_b32 s42, s42, 0x7ff00000
    s_cmp_eq_u32 s7, 7
    s_cselect_b32 s48, 0, s7
    s_lshl_b32 s48, s48, 12
    s_add_u32 s49, s48, 4096
    s_cmp_eq_u32 s49, 28672
    s_cselect_b32 s49, 0, s49
    s_add_u32 s50, s49, 4096
    s_cmp_eq_u32 s50, 28672
    s_cselect_b32 s50, 0, s50
    s_add_u32 s51, s50, 4096
    s_cmp_eq_u32 s51, 28672
    s_cselect_b32 s51, 0, s51
    s_add_u32 s52, s51, 4096
    s_cmp_eq_u32 s52, 28672
    s_cselect_b32 s52, 0, s52
    s_add_u32 s53, s52, 4096
    s_cmp_eq_u32 s53, 28672
    s_cselect_b32 s53, 0, s53
    s_add_u32 s54, s53, 4096
    s_cmp_eq_u32 s54, 28672
    s_cselect_b32 s54, 0, s54
    v_lshrrev_b32 v14, 5, v1
    v_lshlrev_b32 v6, 12, v14
    v_bfe_u32 v13, v1, 2, 2
    v_lshl_add_u32 v6, v13, 10, v6
    v_lshlrev_b32 v10, 6, v13
    v_lshl_add_u32 v10, v14, 10, v10
    v_xor_b32 v13, s3, v3
    v_and_b32 v13, 1, v13
    v_lshl_add_u32 v6, v13, 6, v6
    v_and_b32 v13, 3, v1
    v_lshl_add_u32 v6, v13, 4, v6
    s_mul_i32 s43, s3, 458752
    s_lshl_b32 s44, s7, 7
    s_add_u32 s43, s43, s44
    v_add_u32 v6, s43, v6
    v_add_u32 v7, 7168, v6
    v_add_u32 v8, 14336, v6
    v_add_u32 v9, 21504, v6
    v_and_b32 v14, 1, v1
    v_lshl_add_u32 v10, v14, 5, v10
    v_and_b32 v14, 1, v3
    v_lshl_add_u32 v10, v14, 4, v10
    v_bfe_u32 v14, v1, 1, 1
    v_lshl_add_u32 v10, v14, 3, v10
    v_lshl_add_u32 v5, s3, 4, v2
    v_cvt_f32_u32 v56, v3
    v_mul_f32 v56, 4.0, v56
    v_and_b32 v57, 1, v2
    v_mul_u32_u24 v57, 0x8000, v57
    v_lshl_or_b32 v57, v57, 16, v57
    v_cvt_f32_u32 v13, v5
    v_mul_f32 v13, 0x3c800000, v13
    v_mul_f32 v58, v13, v56
    v_fmamk_f32 v62, v13, 0x41800000, v58
    v_add_f32 v59, v58, v13
    v_add_f32 v63, v62, v13
    v_add_f32 v60, v59, v13
    v_add_f32 v64, v63, v13
    v_add_f32 v61, v60, v13
    v_add_f32 v65, v64, v13
    v_cos_f32 v66, v58
    v_sin_f32 v74, v58
    v_cos_f32 v67, v59
    v_sin_f32 v75, v59
    v_cos_f32 v68, v60
    v_sin_f32 v76, v60
    v_cos_f32 v69, v61
    v_sin_f32 v77, v61
    v_cos_f32 v70, v62
    v_sin_f32 v78, v62
    v_cos_f32 v71, v63
    v_sin_f32 v79, v63
    v_cos_f32 v72, v64
    v_sin_f32 v80, v64
    v_cos_f32 v73, v65
    v_sin_f32 v81, v65
    v_cvt_pk_f16_f32 v176, v66, v67
    v_cvt_pk_f16_f32 v184, v74, v75
    v_cvt_pk_f16_f32 v192, -v74, -v75
    v_cvt_pk_f16_f32 v177, v68, v69
    v_cvt_pk_f16_f32 v185, v76, v77
    v_cvt_pk_f16_f32 v193, -v76, -v77
    v_cvt_pk_f16_f32 v178, v70, v71
    v_cvt_pk_f16_f32 v186, v78, v79
    v_cvt_pk_f16_f32 v194, -v78, -v79
    v_cvt_pk_f16_f32 v179, v72, v73
    v_cvt_pk_f16_f32 v187, v80, v81
    v_cvt_pk_f16_f32 v195, -v80, -v81
    v_xor_b32 v180, v57, v176
    v_xor_b32 v181, v57, v177
    v_xor_b32 v182, v57, v178
    v_xor_b32 v183, v57, v179
    v_xor_b32 v188, v57, v184
    v_xor_b32 v189, v57, v185
    v_xor_b32 v190, v57, v186
    v_xor_b32 v191, v57, v187
    v_xor_b32 v196, v57, v192
    v_xor_b32 v197, v57, v193
    v_xor_b32 v198, v57, v194
    v_xor_b32 v199, v57, v195
    v_cvt_pk_bf16_f32 v200, v66, v67
    v_cvt_pk_bf16_f32 v208, v74, v75
    v_cvt_pk_bf16_f32 v216, -v74, -v75
    v_cvt_pk_bf16_f32 v201, v68, v69
    v_cvt_pk_bf16_f32 v209, v76, v77
    v_cvt_pk_bf16_f32 v217, -v76, -v77
    v_cvt_pk_bf16_f32 v202, v70, v71
    v_cvt_pk_bf16_f32 v210, v78, v79
    v_cvt_pk_bf16_f32 v218, -v78, -v79
    v_cvt_pk_bf16_f32 v203, v72, v73
    v_cvt_pk_bf16_f32 v211, v80, v81
    v_cvt_pk_bf16_f32 v219, -v80, -v81
    v_xor_b32 v204, v57, v200
    v_xor_b32 v205, v57, v201
    v_xor_b32 v206, v57, v202
    v_xor_b32 v207, v57, v203
    v_xor_b32 v212, v57, v208
    v_xor_b32 v213, v57, v209
    v_xor_b32 v214, v57, v210
    v_xor_b32 v215, v57, v211
    v_xor_b32 v220, v57, v216
    v_xor_b32 v221, v57, v217
    v_xor_b32 v222, v57, v218
    v_xor_b32 v223, v57, v219
    v_mul_f32 v58, 0x3d000000, v58
    v_mul_f32 v59, 0x3d000000, v59
    v_mul_f32 v60, 0x3d000000, v60
    v_mul_f32 v61, 0x3d000000, v61
    v_mul_f32 v62, 0x3d000000, v62
    v_mul_f32 v63, 0x3d000000, v63
    v_mul_f32 v64, 0x3d000000, v64
    v_mul_f32 v65, 0x3d000000, v65
    v_cos_f32 v224, v58
    v_sin_f32 v232, v58
    v_cos_f32 v225, v59
    v_sin_f32 v233, v59
    v_cos_f32 v226, v60
    v_sin_f32 v234, v60
    v_cos_f32 v227, v61
    v_sin_f32 v235, v61
    v_cos_f32 v228, v62
    v_sin_f32 v236, v62
    v_cos_f32 v229, v63
    v_sin_f32 v237, v63
    v_cos_f32 v230, v64
    v_sin_f32 v238, v64
    v_cos_f32 v231, v65
    v_sin_f32 v239, v65
    v_xor_b32 v138, v57, v136
    v_xor_b32 v139, v57, v137
    v_xor_b32 v140, 0x80000000, v136
    v_xor_b32 v141, 0x80000000, v137
    v_xor_b32 v142, 0x80000000, v138
    v_xor_b32 v143, 0x80000000, v139
    v_xor_b32 v154, v57, v152
    v_xor_b32 v155, v57, v153
    v_xor_b32 v156, 0x80000000, v152
    v_xor_b32 v157, 0x80000000, v153
    v_xor_b32 v158, 0x80000000, v154
    v_xor_b32 v159, 0x80000000, v155
    v_xor_b32 v162, v57, v160
    v_xor_b32 v163, v57, v161
    v_xor_b32 v164, 0x80000000, v160
    v_xor_b32 v165, 0x80000000, v161
    v_xor_b32 v166, 0x80000000, v162
    v_xor_b32 v167, 0x80000000, v163
    v_xor_b32 v170, v57, v168
    v_xor_b32 v171, v57, v169
    v_xor_b32 v172, 0x80000000, v168
    v_xor_b32 v173, 0x80000000, v169
    v_xor_b32 v174, 0x80000000, v170
    v_xor_b32 v175, 0x80000000, v171
    s_waitcnt vmcnt(9)
    ds_read_b64_tr_b16 v[56:57], v40 offset:0
    ds_read_b64_tr_b16 v[58:59], v40 offset:512
    ds_read_b64_tr_b16 v[60:61], v40 offset:1024
    ds_read_b64_tr_b16 v[62:63], v40 offset:1536
    v_lshlrev_b32 v44, 3, v0
    v_lshrrev_b32 v50, 2, v1
    v_lshl_add_u32 v43, s3, 6, v50
    v_lshlrev_b32 v51, 3, v43
    v_and_b32 v49, 1, v1
    v_lshl_add_u32 v51, v49, 2, v51
    s_add_u32 m0, s99, 0
    s_add_u32 s58, s97, 0
    buffer_load_dwordx4 v15, s[24:27], s58 offen  lds
    v_bfe_u32 v49, v1, 1, 1
    v_mul_u32_u24 v49, 8256, v49
    v_add_u32 v51, v51, v49
    v_mul_u32_u24 v43, 16640, v43
    s_lshr_b32 s43, s2, 2
    v_xor_b32 v49, s43, v1
    v_and_b32 v49, 3, v49
    s_waitcnt lgkmcnt(0)
    v_readfirstlane_b32 s44, v56
    v_readfirstlane_b32 s46, v60
    v_lshlrev_b32 v72, 16, v56
    v_and_b32 v73, 0xffff0000, v56
    v_lshlrev_b32 v74, 16, v57
    v_and_b32 v75, 0xffff0000, v57
    v_lshlrev_b32 v76, 16, v58
    v_and_b32 v77, 0xffff0000, v58
    v_lshlrev_b32 v78, 16, v59
    v_and_b32 v79, 0xffff0000, v59
    s_lshl_b32 s44, s44, 16
    v_lshlrev_b32 v80, 16, v60
    v_and_b32 v81, 0xffff0000, v60
    v_lshlrev_b32 v82, 16, v61
    v_and_b32 v83, 0xffff0000, v61
    v_lshlrev_b32 v84, 16, v62
    v_and_b32 v85, 0xffff0000, v62
    s_add_u32 m0, s99, 1024
    s_add_u32 s58, s97, 114688
    buffer_load_dwordx4 v15, s[24:27], s58 offen  lds
    v_lshlrev_b32 v86, 16, v63
    v_and_b32 v87, 0xffff0000, v63
    s_lshl_b32 s46, s46, 16
    v_pk_add_f32 v[72:73], v[72:73], s[44:45] op_sel_hi:[1,0] neg_lo:[0,1] neg_hi:[0,1]
    v_pk_add_f32 v[74:75], v[74:75], s[44:45] op_sel_hi:[1,0] neg_lo:[0,1] neg_hi:[0,1]
    v_pk_add_f32 v[76:77], v[76:77], s[44:45] op_sel_hi:[1,0] neg_lo:[0,1] neg_hi:[0,1]
    v_pk_add_f32 v[78:79], v[78:79], s[44:45] op_sel_hi:[1,0] neg_lo:[0,1] neg_hi:[0,1]
    v_pk_add_f32 v[80:81], v[80:81], s[46:47] op_sel_hi:[1,0] neg_lo:[0,1] neg_hi:[0,1]
    v_pk_add_f32 v[82:83], v[82:83], s[46:47] op_sel_hi:[1,0] neg_lo:[0,1] neg_hi:[0,1]
    v_pk_add_f32 v[84:85], v[84:85], s[46:47] op_sel_hi:[1,0] neg_lo:[0,1] neg_hi:[0,1]
    v_pk_add_f32 v[86:87], v[86:87], s[46:47] op_sel_hi:[1,0] neg_lo:[0,1] neg_hi:[0,1]
    v_pk_add_f32 v[88:89], v[72:73], v[74:75]
    v_pk_mul_f32 v[92:93], v[72:73], v[72:73]
    v_pk_add_f32 v[90:91], v[80:81], v[82:83]
    v_pk_mul_f32 v[94:95], v[80:81], v[80:81]
    v_pk_fma_f32 v[92:93], v[74:75], v[74:75], v[92:93]
    v_pk_fma_f32 v[94:95], v[82:83], v[82:83], v[94:95]
    v_pk_add_f32 v[88:89], v[88:89], v[76:77]
    v_pk_fma_f32 v[92:93], v[76:77], v[76:77], v[92:93]
    v_pk_add_f32 v[90:91], v[90:91], v[84:85]
    v_pk_fma_f32 v[94:95], v[84:85], v[84:85], v[94:95]
    v_pk_add_f32 v[88:89], v[88:89], v[78:79]
    v_pk_fma_f32 v[92:93], v[78:79], v[78:79], v[92:93]
    v_pk_add_f32 v[90:91], v[90:91], v[86:87]
    v_pk_fma_f32 v[94:95], v[86:87], v[86:87], v[94:95]
    s_add_u32 m0, s99, 2048
    s_add_u32 s58, s97, 229376
    buffer_load_dwordx4 v15, s[24:27], s58 offen  lds
    v_add_f32 v120, v88, v89
    v_add_f32 v122, v92, v93
    v_add_f32 v121, v90, v91
    v_add_f32 v123, v94, v95
    v_lshl_add_u32 v43, v49, 4, v43
    v_add_u32 v52, 128, v51
    v_permlane32_swap_b32 v120, v121
    v_permlane32_swap_b32 v122, v123
    v_add_f32 v120, v120, v121
    v_add_f32 v122, v122, v123
    v_add_u32 v53, 256, v51
    v_add_u32 v54, 384, v51
    v_permlane16_swap_b32 v120, v122
    v_add_f32 v120, v120, v122
    v_mul_u32_u24 v48, 80, v1
    v_add_u32 v48, s99, v48
    v_add_f32_dpp v120, v120, v120 row_shr:1 row_mask:0xf bank_mask:0xf bound_ctrl:0
    v_mul_u32_u24 v49, 80, v50
    v_add_u32 v49, s99, v49
    v_add_f32_dpp v120, v120, v120 row_shr:2 row_mask:0xf bank_mask:0xf bound_ctrl:0
    v_lshlrev_b32 v50, 9, v50
    v_and_b32 v127, 3, v1
    v_add_f32_dpp v120, v120, v120 row_shr:4 row_mask:0xf bank_mask:0xf bound_ctrl:0
    v_lshl_add_u32 v49, v127, 4, v49
    v_lshl_add_u32 v50, v127, 4, v50
    s_add_u32 m0, s99, 3072
    s_add_u32 s58, s97, 344064
    buffer_load_dwordx4 v15, s[24:27], s58 offen  lds
    v_add_f32_dpp v120, v120, v120 row_shr:8 row_mask:0xf bank_mask:0xf bound_ctrl:0
    v_mul_f32 v120, 0x3b000000, v120
    v_mov_b32 v14, 0x3727c5ac
    v_readlane_b32 s16, v120, 15
    v_readlane_b32 s17, v120, 47
    v_readlane_b32 s18, v120, 31
    v_readlane_b32 s19, v120, 63
    s_lshl_b32 s43, s3, 3
    v_mov_b32 v124, s16
    v_mov_b32 v125, s17
    v_fma_f32 v126, -v124, v124, s18
    v_fma_f32 v127, -v125, v125, s19
    v_max_f32 v126, 0, v126
    v_max_f32 v127, 0, v127
    v_add_f32 v126, v126, v14
    v_add_f32 v127, v127, v14
    v_rsq_f32 v120, v126
    v_rsq_f32 v121, v127
    v_mov_b32 v13, s43
    v_mul_f32 v88, 0x3d800000, v120
    v_mul_f32 v90, 0x3d800000, v121
    v_mul_f32 v89, -v124, v88
    v_mul_f32 v91, -v125, v90
    v_pk_fma_f32 v[72:73], v[72:73], v[88:89], v[88:89] op_sel:[0,0,1] op_sel_hi:[1,0,1]
    v_pk_fma_f32 v[74:75], v[74:75], v[88:89], v[88:89] op_sel:[0,0,1] op_sel_hi:[1,0,1]
    v_pk_fma_f32 v[76:77], v[76:77], v[88:89], v[88:89] op_sel:[0,0,1] op_sel_hi:[1,0,1]
    v_pk_fma_f32 v[78:79], v[78:79], v[88:89], v[88:89] op_sel:[0,0,1] op_sel_hi:[1,0,1]
    v_cvt_pk_f16_f32 v56, v72, v73
    v_cvt_pk_f16_f32 v57, v74, v75
    v_cvt_pk_f16_f32 v58, v76, v77
    v_cvt_pk_f16_f32 v59, v78, v79
    v_pk_fma_f32 v[80:81], v[80:81], v[90:91], v[90:91] op_sel:[0,0,1] op_sel_hi:[1,0,1]
    v_pk_fma_f32 v[82:83], v[82:83], v[90:91], v[90:91] op_sel:[0,0,1] op_sel_hi:[1,0,1]
    v_pk_fma_f32 v[84:85], v[84:85], v[90:91], v[90:91] op_sel:[0,0,1] op_sel_hi:[1,0,1]
    v_pk_fma_f32 v[86:87], v[86:87], v[90:91], v[90:91] op_sel:[0,0,1] op_sel_hi:[1,0,1]
    v_cvt_pk_f16_f32 v60, v80, v81
    v_cvt_pk_f16_f32 v61, v82, v83
    v_cvt_pk_f16_f32 v62, v84, v85
    v_cvt_pk_f16_f32 v63, v86, v87
    v_mfma_f32_16x16x32_f16 v[88:91], v[56:59], v[128:131], 0
    v_mul_f32 v126, v126, v120
    v_mfma_f32_16x16x32_f16 v[92:95], v[56:59], v[144:147], 0
    v_add_f32 v124, s44, v124
    v_mfma_f32_16x16x32_f16 v[96:99], v[56:59], v[132:135], 0
    v_mul_f32 v127, v127, v121
    v_mfma_f32_16x16x32_f16 v[100:103], v[56:59], v[148:151], 0
    v_add_f32 v125, s46, v125
    v_mfma_f32_16x16x32_f16 v[104:107], v[60:63], v[128:131], 0
    ds_write_b64 v13, v[124:125] offset:16448
    v_mfma_f32_16x16x32_f16 v[108:111], v[60:63], v[144:147], 0
    ds_write_b64 v13, v[126:127] offset:16480
    v_mfma_f32_16x16x32_f16 v[112:115], v[60:63], v[132:135], 0
    v_mfma_f32_16x16x32_f16 v[116:119], v[60:63], v[148:151], 0
    v_pk_mul_f32 v[72:73], v[88:89], v[16:17]
    v_pk_mul_f32 v[76:77], v[92:93], v[16:17]
    v_pk_mul_f32 v[74:75], v[90:91], v[18:19]
    v_pk_mul_f32 v[78:79], v[94:95], v[18:19]
    v_pk_fma_f32 v[72:73], v[92:93], v[24:25], v[72:73]
    v_pk_fma_f32 v[76:77], v[88:89], v[24:25], v[76:77] neg_lo:[1,0,0] neg_hi:[1,0,0]
    v_pk_fma_f32 v[74:75], v[94:95], v[26:27], v[74:75]
    v_pk_fma_f32 v[78:79], v[90:91], v[26:27], v[78:79] neg_lo:[1,0,0] neg_hi:[1,0,0]
    v_cvt_pk_f16_f32 v88, v72, v73
    v_cvt_pk_f16_f32 v89, v74, v75
    v_cvt_pk_f16_f32 v90, v76, v77
    v_cvt_pk_f16_f32 v91, v78, v79
    v_pk_mul_f32 v[72:73], v[96:97], v[20:21]
    v_pk_mul_f32 v[76:77], v[100:101], v[20:21]
    v_pk_mul_f32 v[74:75], v[98:99], v[22:23]
    v_pk_mul_f32 v[78:79], v[102:103], v[22:23]
    v_pk_fma_f32 v[72:73], v[100:101], v[28:29], v[72:73]
    v_pk_fma_f32 v[76:77], v[96:97], v[28:29], v[76:77] neg_lo:[1,0,0] neg_hi:[1,0,0]
    v_pk_fma_f32 v[74:75], v[102:103], v[30:31], v[74:75]
    v_pk_fma_f32 v[78:79], v[98:99], v[30:31], v[78:79] neg_lo:[1,0,0] neg_hi:[1,0,0]
    v_cvt_pk_f16_f32 v96, v72, v73
    v_cvt_pk_f16_f32 v97, v74, v75
    v_cvt_pk_f16_f32 v98, v76, v77
    v_cvt_pk_f16_f32 v99, v78, v79
    v_mfma_f32_16x16x32_f16 v[92:95], v[32:35], v[88:91], 0
    s_nop 0
    v_mfma_f32_16x16x32_f16 v[100:103], v[32:35], v[96:99], 0
    v_pk_mul_f32 v[80:81], v[104:105], v[16:17]
    v_pk_mul_f32 v[84:85], v[108:109], v[16:17]
    v_pk_mul_f32 v[82:83], v[106:107], v[18:19]
    v_pk_mul_f32 v[86:87], v[110:111], v[18:19]
    v_pk_fma_f32 v[80:81], v[108:109], v[24:25], v[80:81]
    v_pk_fma_f32 v[84:85], v[104:105], v[24:25], v[84:85] neg_lo:[1,0,0] neg_hi:[1,0,0]
    v_pk_fma_f32 v[82:83], v[110:111], v[26:27], v[82:83]
    v_pk_fma_f32 v[86:87], v[106:107], v[26:27], v[86:87] neg_lo:[1,0,0] neg_hi:[1,0,0]
    v_cvt_pk_f16_f32 v104, v80, v81
    v_cvt_pk_f16_f32 v105, v82, v83
    v_cvt_pk_f16_f32 v106, v84, v85
    v_cvt_pk_f16_f32 v107, v86, v87
    v_pk_mul_f32 v[80:81], v[112:113], v[20:21]
    v_pk_mul_f32 v[84:85], v[116:117], v[20:21]
    v_pk_mul_f32 v[82:83], v[114:115], v[22:23]
    v_pk_mul_f32 v[86:87], v[118:119], v[22:23]
    v_pk_fma_f32 v[80:81], v[116:117], v[28:29], v[80:81]
    v_pk_fma_f32 v[84:85], v[112:113], v[28:29], v[84:85] neg_lo:[1,0,0] neg_hi:[1,0,0]
    v_pk_fma_f32 v[82:83], v[118:119], v[30:31], v[82:83]
    v_pk_fma_f32 v[86:87], v[114:115], v[30:31], v[86:87] neg_lo:[1,0,0] neg_hi:[1,0,0]
    v_cvt_pk_f16_f32 v112, v80, v81
    v_cvt_pk_f16_f32 v113, v82, v83
    v_cvt_pk_f16_f32 v114, v84, v85
    v_cvt_pk_f16_f32 v115, v86, v87
    v_mfma_f32_16x16x32_f16 v[108:111], v[32:35], v[104:107], 0
    s_nop 0
    v_mfma_f32_16x16x32_f16 v[116:119], v[32:35], v[112:115], 0
    s_lshl_b32 s47, s2, 6
    s_add_u32 s47, s47, 0x410000
    s_cmp_eq_u32 s3, 2
    s_cselect_b32 s47, s47, 0x7ff00000
    v_pk_mul_f32 v[92:93], v[92:93], v[36:37]
    v_pk_mul_f32 v[94:95], v[94:95], v[38:39]
    v_pk_mul_f32 v[108:109], v[108:109], v[36:37]
    v_pk_mul_f32 v[110:111], v[110:111], v[38:39]
    v_cvt_pk_f16_f32 v72, v92, v108
    v_cvt_pk_f16_f32 v73, v93, v109
    v_cvt_pk_f16_f32 v74, v94, v110
    v_cvt_pk_f16_f32 v75, v95, v111
    ds_write_b128 v41, v[72:75] offset:0
    v_cvt_pk_f16_f32 v76, v100, v116
    v_cvt_pk_f16_f32 v77, v101, v117
    v_cvt_pk_f16_f32 v78, v102, v118
    v_cvt_pk_f16_f32 v79, v103, v119
    ds_write_b128 v41, v[76:79] offset:16
    s_and_b32 s43, s2, 0xed
    s_bfe_u32 s44, s2, 0x10001
    s_lshl_b32 s44, s44, 4
    s_or_b32 s43, s43, s44
    s_bfe_u32 s44, s2, 0x10004
    s_lshl_b32 s44, s44, 1
    s_or_b32 s43, s43, s44
    s_lshl_b32 s43, s43, 6
    s_add_u32 s44, s43, 266240
    s_add_u32 s45, s43, 532480
    s_add_u32 s46, s43, 798720
    s_waitcnt vmcnt(7)
    s_waitcnt lgkmcnt(0)
    s_barrier
    ds_read_u16 v240, v42 offset:16640
    ds_read_u16 v248, v42 offset:20992
    ds_read_u16 v241, v42 offset:18696
    ds_read_u16 v249, v42 offset:23048
    ds_read_u16 v242, v42 offset:17154
    ds_read_u16 v250, v42 offset:21506
    ds_read_u16 v243, v42 offset:19210
    ds_read_u16 v251, v42 offset:23562
    ds_read_u16 v244, v42 offset:17668
    ds_read_u16 v252, v42 offset:22020
    ds_read_u16 v245, v42 offset:19724
    ds_read_u16 v253, v42 offset:24076
    ds_read_u16 v246, v42 offset:18182
    ds_read_u16 v254, v42 offset:22534
    ds_read_u16 v247, v42 offset:20238
    ds_read_u16 v255, v42 offset:24590
    s_cmp_eq_u32 s59, 3
    s_cselect_b32 s40, 0, 0x7ff00000
    v_mov_b32 v13, 1
    v_mov_b32 v14, 0
    buffer_store_dword v13, v14, s[32:35], s40 offen sc1
    v_mov_b32 v120, -1.0
    v_mov_b32 v121, -1.0
    v_mov_b32 v122, -1.0
    v_mov_b32 v123, -1.0
    s_mov_b32 exec_lo, 0xff
    s_mov_b32 exec_hi, 0x0
    buffer_store_dwordx4 v[120:123], v4, s[12:15], s100 offen sc1
    s_mov_b64 exec, 1
    buffer_store_dword v14, v14, s[12:15], s101 offen sc1
    s_mov_b64 exec, -1
    v_mov_b32 v15, 0
    s_lshl_b32 s8, s96, 15
    s_lshl_b32 s9, s3, 2
    s_add_u32 s9, s9, s98
    s_lshl_b32 s9, s9, 4
    s_add_u32 s8, s8, s9
    s_add_u32 s8, s8, 0x8c0000
    s_add_u32 s9, s8, 8192
    s_add_u32 s10, s8, 16384
    s_add_u32 s11, s8, 24576
    s_lshl_b32 s41, s59, 11
    v_mov_b32 v120, 0
    v_mov_b32 v121, 0
    v_mov_b32 v122, 0
    v_mov_b32 v123, 0
    s_waitcnt lgkmcnt(12)
    v_lshl_or_b32 v240, v248, 16, v240
    v_lshl_or_b32 v241, v249, 16, v241
    ds_write_b64 v44, v[240:241] offset:8256
    s_waitcnt lgkmcnt(9)
    v_lshl_or_b32 v242, v250, 16, v242
    v_lshl_or_b32 v243, v251, 16, v243
    ds_write_b64 v44, v[242:243] offset:10304
    s_waitcnt lgkmcnt(6)
    v_lshl_or_b32 v244, v252, 16, v244
    v_lshl_or_b32 v245, v253, 16, v245
    ds_write_b64 v44, v[244:245] offset:12352
    s_waitcnt lgkmcnt(3)
    v_lshl_or_b32 v246, v254, 16, v246
    v_lshl_or_b32 v247, v255, 16, v247
    ds_write_b64 v44, v[246:247] offset:14400
    ds_read2st64_b32 v[240:241], v51 offset0:0 offset1:8
    ds_read2st64_b32 v[242:243], v51 offset0:16 offset1:24
    ds_read2st64_b32 v[244:245], v52 offset0:0 offset1:8
    ds_read2st64_b32 v[246:247], v52 offset0:16 offset1:24
    ds_read2st64_b32 v[248:249], v53 offset0:0 offset1:8
    ds_read2st64_b32 v[250:251], v53 offset0:16 offset1:24
    ds_read2st64_b32 v[252:253], v54 offset0:0 offset1:8
    ds_read2st64_b32 v[254:255], v54 offset0:16 offset1:24
    ds_read_b128 v[124:127], v4 offset:16448
    s_waitcnt lgkmcnt(7)
    buffer_store_dwordx4 v[240:243], v43, s[12:15], s43 offen sc1
    s_waitcnt lgkmcnt(5)
    buffer_store_dwordx4 v[244:247], v43, s[12:15], s44 offen sc1
    s_waitcnt lgkmcnt(3)
    buffer_store_dwordx4 v[248:251], v43, s[12:15], s45 offen sc1
    s_waitcnt lgkmcnt(1)
    buffer_store_dwordx4 v[252:255], v43, s[12:15], s46 offen sc1
    s_waitcnt lgkmcnt(0)
    s_mov_b32 exec_lo, 0xf
    s_mov_b32 exec_hi, 0x0
    buffer_store_dwordx4 v[124:127], v4, s[12:15], s47 offen sc1
    s_mov_b64 exec, 1
    buffer_load_dword v12, v15, s[32:35], 0 offen
    s_mov_b64 exec, -1
    s_waitcnt vmcnt(9)
    ds_read_b64_tr_b16 v[56:57], v46 offset:0
    ds_read_b64_tr_b16 v[58:59], v46 offset:2048
    ds_read_b64_tr_b16 v[60:61], v46 offset:128
    ds_read_b64_tr_b16 v[62:63], v46 offset:2176
    ds_read_b64_tr_b16 v[64:65], v46 offset:256
    ds_read_b64_tr_b16 v[66:67], v46 offset:2304
    ds_read_b64_tr_b16 v[68:69], v46 offset:384
    ds_read_b64_tr_b16 v[70:71], v46 offset:2432
    s_waitcnt lgkmcnt(7)
    ds_write_b64 v45, v[56:57] offset:40960
    s_waitcnt lgkmcnt(7)
    ds_write_b64 v45, v[58:59] offset:41216
    s_waitcnt lgkmcnt(7)
    ds_write_b64 v45, v[60:61] offset:41024
    s_waitcnt lgkmcnt(7)
    ds_write_b64 v45, v[62:63] offset:41280
    s_waitcnt lgkmcnt(7)
    ds_write_b64 v45, v[64:65] offset:41088
    s_waitcnt lgkmcnt(7)
    ds_write_b64 v45, v[66:67] offset:41344
    s_waitcnt lgkmcnt(7)
    ds_write_b64 v45, v[68:69] offset:41152
    s_waitcnt lgkmcnt(7)
    ds_write_b64 v45, v[70:71] offset:41408
    buffer_load_dwordx4 a[240:243], v4, s[28:31], s41 offen
    buffer_load_dwordx4 a[244:247], v4, s[28:31], s41 offen offset:1024
    s_waitcnt lgkmcnt(0)
    s_barrier
    ds_read_b128 v[56:59], v47 offset:8192
    ds_read_b128 v[60:63], v47 offset:9232
    ds_read_b128 v[64:67], v47 offset:10272
    ds_read_b128 v[68:71], v47 offset:11312
    s_waitcnt lgkmcnt(0)
    s_cmp_lt_u32 s56, 224
    s_cbranch_scc1 p_bx
    s_lshr_b32 s16, s98, 2
    s_add_u32 s16, s16, s3
    s_and_b32 s17, s16, 1
    s_lshl_b32 s17, s17, 4
    s_lshr_b32 s16, s16, 1
    s_lshl_b32 s16, s16, 2
    s_add_u32 s16, s16, s17
    s_sub_u32 s17, s96, 112
    s_lshl_b32 s17, s17, 5
    s_add_u32 s16, s16, s17
    s_bfe_u32 s17, s16, 0x20006
    s_lshl_b32 s17, s17, 4
    s_and_b32 s18, s16, 15
    s_add_u32 s17, s17, s18
    s_bitcmp1_b32 s16, 4
    s_cselect_b32 s18, 16, 0
    s_lshl_b32 s18, 0x3f80, s18
    s_lshr_b32 s19, s16, 8
    s_lshl_b32 s19, s19, 1
    s_bfe_u32 s20, s16, 0x10005
    s_add_u32 s19, s19, s20
    s_cmp_eq_u32 s19, 0
    s_cselect_b32 s20, s18, 0
    s_cmp_eq_u32 s19, 1
    s_cselect_b32 s21, s18, 0
    s_cmp_eq_u32 s19, 2
    s_cselect_b32 s22, s18, 0
    s_cmp_eq_u32 s19, 3
    s_cselect_b32 s23, s18, 0
    v_subrev_u32 v13, s17, v1
    v_mov_b32 v72, s20
    v_mov_b32 v73, s21
    v_mov_b32 v74, s22
    v_mov_b32 v75, s23
    v_cmp_eq_u32 vcc, 0, v13
    s_nop 1
    v_cndmask_b32 v56, 0, v72, vcc
    v_cndmask_b32 v57, 0, v73, vcc
    v_cndmask_b32 v58, 0, v74, vcc
    v_cndmask_b32 v59, 0, v75, vcc
    v_cmp_eq_u32 vcc, 1, v13
    s_nop 1
    v_cndmask_b32 v60, 0, v72, vcc
    v_cndmask_b32 v61, 0, v73, vcc
    v_cndmask_b32 v62, 0, v74, vcc
    v_cndmask_b32 v63, 0, v75, vcc
    v_cmp_eq_u32 vcc, 2, v13
    s_nop 1
    v_cndmask_b32 v64, 0, v72, vcc
    v_cndmask_b32 v65, 0, v73, vcc
    v_cndmask_b32 v66, 0, v74, vcc
    v_cndmask_b32 v67, 0, v75, vcc
    v_cmp_eq_u32 vcc, 3, v13
    s_nop 1
    v_cndmask_b32 v68, 0, v72, vcc
    v_cndmask_b32 v69, 0, v73, vcc
    v_cndmask_b32 v70, 0, v74, vcc
    v_cndmask_b32 v71, 0, v75, vcc
p_bx:
    v_dot2_f32_bf16 v120, v56, v56, v120
    v_dot2_f32_bf16 v121, v60, v60, v121
    v_dot2_f32_bf16 v122, v64, v64, v122
    v_dot2_f32_bf16 v123, v68, v68, v123
    v_dot2_f32_bf16 v120, v57, v57, v120
    v_dot2_f32_bf16 v121, v61, v61, v121
    v_dot2_f32_bf16 v122, v65, v65, v122
    v_dot2_f32_bf16 v123, v69, v69, v123
    v_dot2_f32_bf16 v120, v58, v58, v120
    v_dot2_f32_bf16 v121, v62, v62, v121
    v_dot2_f32_bf16 v122, v66, v66, v122
    v_dot2_f32_bf16 v123, v70, v70, v123
    v_dot2_f32_bf16 v120, v59, v59, v120
    v_dot2_f32_bf16 v121, v63, v63, v121
    v_dot2_f32_bf16 v122, v67, v67, v122
    v_dot2_f32_bf16 v123, v71, v71, v123
    v_mov_b32 v14, 0x0da24260
    v_lshlrev_b32 v72, 16, v56
    v_and_b32 v73, 0xffff0000, v56
    v_permlane32_swap_b32 v120, v121
    v_permlane32_swap_b32 v122, v123
    v_add_f32 v120, v120, v121
    v_add_f32 v122, v122, v123
    v_lshlrev_b32 v74, 16, v57
    v_and_b32 v75, 0xffff0000, v57
    v_permlane16_swap_b32 v120, v122
    v_add_f32 v120, v120, v122
    v_lshlrev_b32 v76, 16, v58
    v_and_b32 v77, 0xffff0000, v58
    v_add_f32_dpp v120, v120, v120 row_shr:1 row_mask:0xf bank_mask:0xf bound_ctrl:0
    v_lshlrev_b32 v78, 16, v59
    v_and_b32 v79, 0xffff0000, v59
    v_add_f32_dpp v120, v120, v120 row_shr:2 row_mask:0xf bank_mask:0xf bound_ctrl:0
    v_lshlrev_b32 v80, 16, v60
    v_and_b32 v81, 0xffff0000, v60
    v_add_f32_dpp v120, v120, v120 row_shr:4 row_mask:0xf bank_mask:0xf bound_ctrl:0
    v_lshlrev_b32 v82, 16, v61
    v_and_b32 v83, 0xffff0000, v61
    v_add_f32_dpp v120, v120, v120 row_shr:8 row_mask:0xf bank_mask:0xf bound_ctrl:0
    v_lshlrev_b32 v84, 16, v62
    v_and_b32 v85, 0xffff0000, v62
    v_lshlrev_b32 v86, 16, v63
    v_and_b32 v87, 0xffff0000, v63
    v_fmamk_f32 v121, v120, 0x3b000000, v14
    v_rsq_f32 v120, v121
    v_lshlrev_b32 v104, 16, v64
    v_mul_f32 v121, v121, v120
    v_mul_f32 v120, 0x3d800000, v120
    v_and_b32 v105, 0xffff0000, v64
    v_readlane_b32 s16, v120, 15
    v_readlane_b32 s17, v121, 15
    v_readlane_b32 s18, v120, 47
    v_readlane_b32 s19, v121, 47
    v_readlane_b32 s20, v120, 31
    v_readlane_b32 s21, v121, 31
    v_readlane_b32 s22, v120, 63
    v_readlane_b32 s23, v121, 63
    v_lshlrev_b32 v106, 16, v65
    v_and_b32 v107, 0xffff0000, v65
    v_lshlrev_b32 v108, 16, v66
    v_and_b32 v109, 0xffff0000, v66
    v_lshlrev_b32 v110, 16, v67
    v_and_b32 v111, 0xffff0000, v67
    v_lshlrev_b32 v112, 16, v68
    v_and_b32 v113, 0xffff0000, v68
    v_lshlrev_b32 v114, 16, v69
    v_and_b32 v115, 0xffff0000, v69
    v_lshlrev_b32 v116, 16, v70
    v_and_b32 v117, 0xffff0000, v70
    v_lshlrev_b32 v118, 16, v71
    v_and_b32 v119, 0xffff0000, v71
    v_pk_mul_f32 v[104:105], v[104:105], s[20:21] op_sel_hi:[1,0]
    v_pk_mul_f32 v[106:107], v[106:107], s[20:21] op_sel_hi:[1,0]
    v_pk_mul_f32 v[108:109], v[108:109], s[20:21] op_sel_hi:[1,0]
    v_pk_mul_f32 v[110:111], v[110:111], s[20:21] op_sel_hi:[1,0]
    v_cvt_pk_f16_f32 v64, v104, v105
    v_cvt_pk_f16_f32 v65, v106, v107
    v_cvt_pk_f16_f32 v66, v108, v109
    v_cvt_pk_f16_f32 v67, v110, v111
    v_pk_mul_f32 v[112:113], v[112:113], s[22:23] op_sel_hi:[1,0]
    v_pk_mul_f32 v[114:115], v[114:115], s[22:23] op_sel_hi:[1,0]
    v_pk_mul_f32 v[116:117], v[116:117], s[22:23] op_sel_hi:[1,0]
    v_pk_mul_f32 v[118:119], v[118:119], s[22:23] op_sel_hi:[1,0]
    v_cvt_pk_f16_f32 v68, v112, v113
    v_cvt_pk_f16_f32 v69, v114, v115
    v_cvt_pk_f16_f32 v70, v116, v117
    v_cvt_pk_f16_f32 v71, v118, v119
    v_pk_mul_f32 v[72:73], v[72:73], s[16:17] op_sel_hi:[1,0]
    v_pk_mul_f32 v[74:75], v[74:75], s[16:17] op_sel_hi:[1,0]
    v_pk_mul_f32 v[76:77], v[76:77], s[16:17] op_sel_hi:[1,0]
    v_pk_mul_f32 v[78:79], v[78:79], s[16:17] op_sel_hi:[1,0]
    v_cvt_pk_f16_f32 v56, v72, v73
    v_lshlrev_b32 v13, 12, v1
    v_mov_b32 v14, 1
    s_waitcnt vmcnt(2)
    s_barrier
    s_cmp_lg_u32 s3, 0
    s_cbranch_scc1 p_s1
    v_readfirstlane_b32 s43, v12
    s_nop 0
    s_cmp_lg_u32 s43, 0
    s_cbranch_scc1 p_s1
    s_mov_b32 s58, 0
    s_mov_b32 exec_lo, 0x1
    s_mov_b32 exec_hi, 0x0
p_poll0:
    buffer_load_dword v12, v15, s[32:35], 0 offen sc1
    s_add_u32 s58, s58, 1
    s_cmp_ge_u32 s58, 32768
    s_cbranch_scc1 p_poll0_out
    s_waitcnt vmcnt(0)
    v_cmp_gt_u32 vcc, 1, v12
    s_nop 4
    s_cbranch_vccnz p_poll0
p_poll0_out:
    s_waitcnt vmcnt(0)
    s_mov_b64 exec, -1
p_s1:
    s_mov_b32 exec_lo, 0xff
    s_mov_b32 exec_hi, 0x0
    buffer_atomic_add v14, v13, s[12:15], s42 offen sc1
    s_mov_b64 exec, -1
    v_cvt_pk_f16_f32 v57, v74, v75
    v_cvt_pk_f16_f32 v58, v76, v77
    v_cvt_pk_f16_f32 v59, v78, v79
    s_nop 1
    v_mfma_f32_16x16x32_f16 v[88:91], v[56:59], v[128:131], 0
    v_pk_mul_f32 v[80:81], v[80:81], s[18:19] op_sel_hi:[1,0]
    v_pk_mul_f32 v[82:83], v[82:83], s[18:19] op_sel_hi:[1,0]
    v_mfma_f32_16x16x32_f16 v[92:95], v[56:59], v[144:147], 0
    v_pk_mul_f32 v[84:85], v[84:85], s[18:19] op_sel_hi:[1,0]
    s_lshl_b32 s47, s50, 4
    s_add_u32 m0, s99, 16384
    s_nop 0
    buffer_load_dwordx4 v6, s[28:31], s47 offen offset:0  lds
    v_pk_mul_f32 v[86:87], v[86:87], s[18:19] op_sel_hi:[1,0]
    v_mfma_f32_16x16x32_f16 v[96:99], v[56:59], v[132:135], 0
    v_cvt_pk_f16_f32 v60, v80, v81
    v_cvt_pk_f16_f32 v61, v82, v83
    v_mfma_f32_16x16x32_f16 v[100:103], v[56:59], v[148:151], 0
    v_cvt_pk_f16_f32 v62, v84, v85
    v_cvt_pk_f16_f32 v63, v86, v87
    s_nop 1
    v_mfma_f32_16x16x32_f16 v[104:107], v[60:63], v[128:131], 0
    v_mfma_f32_16x16x32_f16 v[108:111], v[60:63], v[144:147], 0
    v_mfma_f32_16x16x32_f16 v[112:115], v[60:63], v[132:135], 0
    buffer_load_dwordx4 v7, s[28:31], s47 offen offset:1024  lds
    v_mfma_f32_16x16x32_f16 v[116:119], v[60:63], v[148:151], 0
    v_pk_mul_f32 v[72:73], v[88:89], v[16:17]
    v_pk_mul_f32 v[76:77], v[92:93], v[16:17]
    v_pk_mul_f32 v[74:75], v[90:91], v[18:19]
    v_pk_mul_f32 v[78:79], v[94:95], v[18:19]
    v_pk_fma_f32 v[72:73], v[92:93], v[24:25], v[72:73]
    v_pk_fma_f32 v[76:77], v[88:89], v[24:25], v[76:77] neg_lo:[1,0,0] neg_hi:[1,0,0]
    v_pk_fma_f32 v[74:75], v[94:95], v[26:27], v[74:75]
    v_pk_fma_f32 v[78:79], v[90:91], v[26:27], v[78:79] neg_lo:[1,0,0] neg_hi:[1,0,0]
    v_cvt_pk_f16_f32 v88, v72, v73
    buffer_load_dwordx4 v8, s[28:31], s47 offen offset:2048  lds
    v_cvt_pk_f16_f32 v89, v74, v75
    v_cvt_pk_f16_f32 v90, v76, v77
    v_cvt_pk_f16_f32 v91, v78, v79
    v_pk_mul_f32 v[72:73], v[96:97], v[20:21]
    v_pk_mul_f32 v[76:77], v[100:101], v[20:21]
    v_pk_mul_f32 v[74:75], v[98:99], v[22:23]
    v_pk_mul_f32 v[78:79], v[102:103], v[22:23]
    v_pk_fma_f32 v[72:73], v[100:101], v[28:29], v[72:73]
    v_pk_fma_f32 v[76:77], v[96:97], v[28:29], v[76:77] neg_lo:[1,0,0] neg_hi:[1,0,0]
    v_pk_fma_f32 v[74:75], v[102:103], v[30:31], v[74:75]
    buffer_load_dwordx4 v9, s[28:31], s47 offen offset:3072  lds
    v_pk_fma_f32 v[78:79], v[98:99], v[30:31], v[78:79] neg_lo:[1,0,0] neg_hi:[1,0,0]
    v_cvt_pk_f16_f32 v96, v72, v73
    v_cvt_pk_f16_f32 v97, v74, v75
    v_cvt_pk_f16_f32 v98, v76, v77
    v_cvt_pk_f16_f32 v99, v78, v79
    v_mfma_f32_16x16x32_f16 v[92:95], v[32:35], v[88:91], 0
    s_nop 0
    v_mfma_f32_16x16x32_f16 v[100:103], v[32:35], v[96:99], 0
    v_pk_mul_f32 v[80:81], v[104:105], v[16:17]
    v_pk_mul_f32 v[84:85], v[108:109], v[16:17]
    v_pk_mul_f32 v[82:83], v[106:107], v[18:19]
    s_lshl_b32 s47, s50, 4
    s_add_u32 s47, s47, 32768
    s_add_u32 m0, s99, 20480
    s_nop 0
    buffer_load_dwordx4 v6, s[28:31], s47 offen offset:0  lds
    v_pk_mul_f32 v[86:87], v[110:111], v[18:19]
    v_pk_fma_f32 v[80:81], v[108:109], v[24:25], v[80:81]
    v_pk_fma_f32 v[84:85], v[104:105], v[24:25], v[84:85] neg_lo:[1,0,0] neg_hi:[1,0,0]
    v_pk_fma_f32 v[82:83], v[110:111], v[26:27], v[82:83]
    v_pk_fma_f32 v[86:87], v[106:107], v[26:27], v[86:87] neg_lo:[1,0,0] neg_hi:[1,0,0]
    v_cvt_pk_f16_f32 v104, v80, v81
    v_cvt_pk_f16_f32 v105, v82, v83
    v_cvt_pk_f16_f32 v106, v84, v85
    v_cvt_pk_f16_f32 v107, v86, v87
    v_pk_mul_f32 v[80:81], v[112:113], v[20:21]
    buffer_load_dwordx4 v7, s[28:31], s47 offen offset:1024  lds
    v_pk_mul_f32 v[84:85], v[116:117], v[20:21]
    v_pk_mul_f32 v[82:83], v[114:115], v[22:23]
    v_pk_mul_f32 v[86:87], v[118:119], v[22:23]
    v_pk_fma_f32 v[80:81], v[116:117], v[28:29], v[80:81]
    v_pk_fma_f32 v[84:85], v[112:113], v[28:29], v[84:85] neg_lo:[1,0,0] neg_hi:[1,0,0]
    v_pk_fma_f32 v[82:83], v[118:119], v[30:31], v[82:83]
    v_pk_fma_f32 v[86:87], v[114:115], v[30:31], v[86:87] neg_lo:[1,0,0] neg_hi:[1,0,0]
    v_cvt_pk_f16_f32 v112, v80, v81
    v_cvt_pk_f16_f32 v113, v82, v83
    v_cvt_pk_f16_f32 v114, v84, v85
    buffer_load_dwordx4 v8, s[28:31], s47 offen offset:2048  lds
    v_cvt_pk_f16_f32 v115, v86, v87
    v_mfma_f32_16x16x32_f16 v[108:111], v[32:35], v[104:107], 0
    s_nop 0
    v_mfma_f32_16x16x32_f16 v[116:119], v[32:35], v[112:115], 0
    v_pk_mul_f32 v[92:93], v[92:93], v[36:37]
    v_pk_mul_f32 v[94:95], v[94:95], v[38:39]
    v_pk_mul_f32 v[92:93], v[92:93], s[16:17] op_sel:[0,1] op_sel_hi:[1,1]
    v_pk_mul_f32 v[94:95], v[94:95], s[16:17] op_sel:[0,1] op_sel_hi:[1,1]
    v_pk_mul_f32 v[100:101], v[100:101], s[16:17] op_sel:[0,1] op_sel_hi:[1,1]
    v_pk_mul_f32 v[102:103], v[102:103], s[16:17] op_sel:[0,1] op_sel_hi:[1,1]
    v_cvt_pk_bf16_f32 v56, v92, v93
    buffer_load_dwordx4 v9, s[28:31], s47 offen offset:3072  lds
    v_cvt_pk_bf16_f32 v57, v94, v95
    v_cvt_pk_bf16_f32 v58, v100, v101
    v_cvt_pk_bf16_f32 v59, v102, v103
    ds_write_b128 v48, v[56:59] offset:0
    v_mfma_f32_16x16x32_f16 v[88:91], v[64:67], v[128:131], 0
    v_pk_mul_f32 v[108:109], v[108:109], v[36:37]
    v_pk_mul_f32 v[110:111], v[110:111], v[38:39]
    v_mfma_f32_16x16x32_f16 v[92:95], v[64:67], v[144:147], 0
    v_pk_mul_f32 v[108:109], v[108:109], s[18:19] op_sel:[0,1] op_sel_hi:[1,1]
    v_pk_mul_f32 v[110:111], v[110:111], s[18:19] op_sel:[0,1] op_sel_hi:[1,1]
    s_lshl_b32 s47, s51, 4
    s_add_u32 m0, s99, 24576
    s_nop 0
    buffer_load_dwordx4 v6, s[28:31], s47 offen offset:0  lds
    v_mfma_f32_16x16x32_f16 v[96:99], v[64:67], v[132:135], 0
    v_pk_mul_f32 v[116:117], v[116:117], s[18:19] op_sel:[0,1] op_sel_hi:[1,1]
    v_pk_mul_f32 v[118:119], v[118:119], s[18:19] op_sel:[0,1] op_sel_hi:[1,1]
    v_mfma_f32_16x16x32_f16 v[100:103], v[64:67], v[148:151], 0
    v_cvt_pk_bf16_f32 v60, v108, v109
    v_cvt_pk_bf16_f32 v61, v110, v111
    v_cvt_pk_bf16_f32 v62, v116, v117
    v_cvt_pk_bf16_f32 v63, v118, v119
    ds_write_b128 v48, v[60:63] offset:16
    v_mfma_f32_16x16x32_f16 v[104:107], v[68:71], v[128:131], 0
    buffer_load_dwordx4 v7, s[28:31], s47 offen offset:1024  lds
    v_mfma_f32_16x16x32_f16 v[108:111], v[68:71], v[144:147], 0
    v_mfma_f32_16x16x32_f16 v[112:115], v[68:71], v[132:135], 0
    v_mfma_f32_16x16x32_f16 v[116:119], v[68:71], v[148:151], 0
    v_pk_mul_f32 v[72:73], v[88:89], v[16:17]
    v_pk_mul_f32 v[76:77], v[92:93], v[16:17]
    v_pk_mul_f32 v[74:75], v[90:91], v[18:19]
    v_pk_mul_f32 v[78:79], v[94:95], v[18:19]
    v_pk_fma_f32 v[72:73], v[92:93], v[24:25], v[72:73]
    v_pk_fma_f32 v[76:77], v[88:89], v[24:25], v[76:77] neg_lo:[1,0,0] neg_hi:[1,0,0]
    v_pk_fma_f32 v[74:75], v[94:95], v[26:27], v[74:75]
    buffer_load_dwordx4 v8, s[28:31], s47 offen offset:2048  lds
    v_pk_fma_f32 v[78:79], v[90:91], v[26:27], v[78:79] neg_lo:[1,0,0] neg_hi:[1,0,0]
    v_cvt_pk_f16_f32 v88, v72, v73
    v_cvt_pk_f16_f32 v89, v74, v75
    v_cvt_pk_f16_f32 v90, v76, v77
    v_cvt_pk_f16_f32 v91, v78, v79
    v_pk_mul_f32 v[72:73], v[96:97], v[20:21]
    v_pk_mul_f32 v[76:77], v[100:101], v[20:21]
    v_pk_mul_f32 v[74:75], v[98:99], v[22:23]
    v_pk_mul_f32 v[78:79], v[102:103], v[22:23]
    v_pk_fma_f32 v[72:73], v[100:101], v[28:29], v[72:73]
    buffer_load_dwordx4 v9, s[28:31], s47 offen offset:3072  lds
    v_pk_fma_f32 v[76:77], v[96:97], v[28:29], v[76:77] neg_lo:[1,0,0] neg_hi:[1,0,0]
    v_pk_fma_f32 v[74:75], v[102:103], v[30:31], v[74:75]
    v_pk_fma_f32 v[78:79], v[98:99], v[30:31], v[78:79] neg_lo:[1,0,0] neg_hi:[1,0,0]
    v_cvt_pk_f16_f32 v96, v72, v73
    v_cvt_pk_f16_f32 v97, v74, v75
    v_cvt_pk_f16_f32 v98, v76, v77
    v_cvt_pk_f16_f32 v99, v78, v79
    v_mfma_f32_16x16x32_f16 v[92:95], v[32:35], v[88:91], 0
    s_nop 0
    v_mfma_f32_16x16x32_f16 v[100:103], v[32:35], v[96:99], 0
    v_pk_mul_f32 v[80:81], v[104:105], v[16:17]
    s_lshl_b32 s47, s51, 4
    s_add_u32 s47, s47, 32768
    s_add_u32 m0, s99, 28672
    s_nop 0
    buffer_load_dwordx4 v6, s[28:31], s47 offen offset:0  lds
    v_pk_mul_f32 v[84:85], v[108:109], v[16:17]
    v_pk_mul_f32 v[82:83], v[106:107], v[18:19]
    v_pk_mul_f32 v[86:87], v[110:111], v[18:19]
    v_pk_fma_f32 v[80:81], v[108:109], v[24:25], v[80:81]
    v_pk_fma_f32 v[84:85], v[104:105], v[24:25], v[84:85] neg_lo:[1,0,0] neg_hi:[1,0,0]
    v_pk_fma_f32 v[82:83], v[110:111], v[26:27], v[82:83]
    v_pk_fma_f32 v[86:87], v[106:107], v[26:27], v[86:87] neg_lo:[1,0,0] neg_hi:[1,0,0]
    v_cvt_pk_f16_f32 v104, v80, v81
    v_cvt_pk_f16_f32 v105, v82, v83
    v_cvt_pk_f16_f32 v106, v84, v85
    buffer_load_dwordx4 v7, s[28:31], s47 offen offset:1024  lds
    v_cvt_pk_f16_f32 v107, v86, v87
    v_pk_mul_f32 v[80:81], v[112:113], v[20:21]
    v_pk_mul_f32 v[84:85], v[116:117], v[20:21]
    v_pk_mul_f32 v[82:83], v[114:115], v[22:23]
    v_pk_mul_f32 v[86:87], v[118:119], v[22:23]
    v_pk_fma_f32 v[80:81], v[116:117], v[28:29], v[80:81]
    v_pk_fma_f32 v[84:85], v[112:113], v[28:29], v[84:85] neg_lo:[1,0,0] neg_hi:[1,0,0]
    v_pk_fma_f32 v[82:83], v[118:119], v[30:31], v[82:83]
    v_pk_fma_f32 v[86:87], v[114:115], v[30:31], v[86:87] neg_lo:[1,0,0] neg_hi:[1,0,0]
    v_cvt_pk_f16_f32 v112, v80, v81
    buffer_load_dwordx4 v8, s[28:31], s47 offen offset:2048  lds
    v_cvt_pk_f16_f32 v113, v82, v83
    v_cvt_pk_f16_f32 v114, v84, v85
    v_cvt_pk_f16_f32 v115, v86, v87
    v_mfma_f32_16x16x32_f16 v[108:111], v[32:35], v[104:107], 0
    s_nop 0
    v_mfma_f32_16x16x32_f16 v[116:119], v[32:35], v[112:115], 0
    v_pk_mul_f32 v[92:93], v[92:93], v[36:37]
    v_pk_mul_f32 v[94:95], v[94:95], v[38:39]
    v_pk_mul_f32 v[92:93], v[92:93], s[20:21] op_sel:[0,1] op_sel_hi:[1,1]
    v_pk_mul_f32 v[94:95], v[94:95], s[20:21] op_sel:[0,1] op_sel_hi:[1,1]
    v_pk_mul_f32 v[100:101], v[100:101], s[20:21] op_sel:[0,1] op_sel_hi:[1,1]
    buffer_load_dwordx4 v9, s[28:31], s47 offen offset:3072  lds
    v_pk_mul_f32 v[102:103], v[102:103], s[20:21] op_sel:[0,1] op_sel_hi:[1,1]
    v_cvt_pk_bf16_f32 v64, v92, v93
    v_cvt_pk_bf16_f32 v65, v94, v95
    v_cvt_pk_bf16_f32 v66, v100, v101
    v_cvt_pk_bf16_f32 v67, v102, v103
    ds_write_b128 v48, v[64:67] offset:32
    v_pk_mul_f32 v[108:109], v[108:109], v[36:37]
    v_pk_mul_f32 v[110:111], v[110:111], v[38:39]
    v_pk_mul_f32 v[108:109], v[108:109], s[22:23] op_sel:[0,1] op_sel_hi:[1,1]
    v_pk_mul_f32 v[110:111], v[110:111], s[22:23] op_sel:[0,1] op_sel_hi:[1,1]
    v_pk_mul_f32 v[116:117], v[116:117], s[22:23] op_sel:[0,1] op_sel_hi:[1,1]
    v_pk_mul_f32 v[118:119], v[118:119], s[22:23] op_sel:[0,1] op_sel_hi:[1,1]
    v_cvt_pk_bf16_f32 v68, v108, v109
    v_cvt_pk_bf16_f32 v69, v110, v111
    v_cvt_pk_bf16_f32 v70, v116, v117
    v_cvt_pk_bf16_f32 v71, v118, v119
    ds_write_b128 v48, v[68:71] offset:48
    ds_read_b128 a[224:227], v49 offset:0
    ds_read_b128 a[228:231], v49 offset:1280
    ds_read_b128 a[232:235], v49 offset:2560
    ds_read_b128 a[236:239], v49 offset:3840
    v_mov_b32 v245, v50
    s_waitcnt lgkmcnt(0)
    s_lshl_b32 s43, s96, 1
    s_lshr_b32 s44, s98, 4
    s_add_u32 s43, s43, s44
    s_lshl_b32 s43, s43, 8
    s_add_u32 s40, s43, 0x470000
    s_cmp_eq_u32 s3, 3
    s_cselect_b32 s40, s40, 0x7ff00000
    s_lshl_b32 s41, s5, 12
    s_add_u32 s41, s41, 0x470000
    s_lshl_b32 s42, s3, 12
    v_add_u32 v248, s99, v10
    v_lshl_add_u32 v250, v5, 2, v3
    v_lshlrev_b32 v255, 4, v250
    v_lshlrev_b32 v244, 5, v250
    v_bfe_u32 v13, v1, 2, 2
    v_mul_u32_u24 v240, 272, v13
    v_bfe_u32 v13, v1, 1, 1
    v_lshl_add_u32 v240, v13, 6, v240
    v_and_b32 v13, 1, v1
    v_lshl_add_u32 v240, v13, 3, v240
    v_lshlrev_b32 v250, 4, v13
    v_lshrrev_b32 v13, 1, v1
    v_lshl_add_u32 v250, v13, 6, v250
    v_and_b32 v13, 1, v3
    v_lshl_add_u32 v240, v13, 7, v240
    v_lshlrev_b32 v252, 6, v13
    v_lshlrev_b32 v254, 11, v13
    v_lshrrev_b32 v13, 1, v3
    v_lshl_add_u32 v240, v13, 11, v240
    v_xor_b32 v241, 16, v240
    v_lshl_add_u32 v252, v13, 10, v252
    v_lshl_add_u32 v254, v13, 3, v254
    v_lshl_add_u32 v254, v5, 5, v254
    v_and_b32 v14, 3, v2
    v_mul_u32_u24 v243, 272, v14
    v_add_u32 v252, v252, v243
    v_lshlrev_b32 v251, 2, v14
    v_bfe_u32 v14, v2, 2, 1
    v_lshl_add_u32 v252, v14, 7, v252
    s_lshr_b32 s44, s3, 1
    v_xor_b32 v14, s44, v14
    v_lshl_add_u32 v251, v14, 4, v251
    v_lshrrev_b32 v14, 3, v2
    v_lshl_add_u32 v252, v14, 11, v252
    v_lshl_add_u32 v251, v14, 6, v251
    v_lshl_add_u32 v251, v3, 11, v251
    s_lshl_b32 s44, s44, 8
    s_and_b32 s45, s3, 1
    s_lshl_b32 s45, s45, 10
    s_add_u32 s44, s44, s45
    v_add_u32 v251, s44, v251
    v_add_u32 v252, s42, v252
    v_xor_b32 v242, 16, v252
    v_lshlrev_b32 v253, 3, v1
    s_mul_i32 s16, s2, 16640
    s_add_u32 s16, s16, s42
    s_add_u32 s18, s42, 0x410020
    s_add_u32 s19, s18, 2048
    s_add_u32 s17, s57, 24576
    s_lshl_b32 s44, s5, 2
    s_add_u32 s44, s44, s3
    s_lshl_b32 s44, s44, 16
    s_add_u32 s44, s44, 0x8c0000
    v_add_u32 v246, s44, v4
    v_add_u32 v247, 0x8000, v246
    s_movk_i32 s24, 4096
    s_movk_i32 s25, 8192
    s_movk_i32 s26, 12288
    s_movk_i32 s27, 16384
    s_movk_i32 s32, 20480
    s_movk_i32 s33, 24576
    s_movk_i32 s34, 28672
    s_mov_b32 m0, s42
    s_mul_i32 s20, s2, 8704
    s_add_u32 s20, s20, 0x490000
    s_add_u32 s21, s20, 4352
    s_cmp_lg_u32 s2, 0
    s_cselect_b32 s22, -1, 0
    s_and_b32 s23, s2, 7
    s_lshl_b32 s23, s23, 12
    s_add_u32 s43, s23, 0x440000
    s_mov_b32 s23, s41
    v_mov_b32 v13, 1
    s_cmp_lg_u32 s3, 0
    s_cbranch_scc1 p_w1
    s_mov_b32 s58, 0
    s_mov_b32 exec_lo, 0xffff
    s_mov_b32 exec_hi, 0x0
p_poll1:
    buffer_load_dword v12, v11, s[12:15], s43 offen sc1
    s_add_u32 s58, s58, 1
    s_cmp_ge_u32 s58, 32768
    s_cbranch_scc1 p_poll1_out
    s_waitcnt vmcnt(0)
    v_cmp_gt_u32 vcc, 16, v12
    s_nop 4
    s_cbranch_vccnz p_poll1
p_poll1_out:
    s_waitcnt vmcnt(0)
    s_mov_b64 exec, -1
p_w1:
    s_barrier
    buffer_load_dwordx4 v4, s[12:15], s16 offen offset:0 sc1 lds
    buffer_load_dwordx4 v4, s[12:15], s16 offen offset:1024 sc1 lds
    buffer_load_dwordx4 v4, s[12:15], s16 offen offset:2048 sc1 lds
    buffer_load_dwordx4 v4, s[12:15], s16 offen offset:3072 sc1 lds
    s_mov_b32 m0, s17
    s_add_u32 s17, s17, 1024
    buffer_load_dwordx4 v250, s[12:15], s18 offen sc1 lds
    s_mov_b32 m0, s17
    s_nop 0
    buffer_load_dwordx4 v250, s[12:15], s19 offen sc1 lds
    s_lshl_b32 s47, s48, 4
    s_add_u32 m0, s99, 0
    s_nop 0
    buffer_load_dwordx4 v6, s[28:31], s47 offen offset:0  lds
    buffer_load_dwordx4 v7, s[28:31], s47 offen offset:1024  lds
    buffer_load_dwordx4 v8, s[28:31], s47 offen offset:2048  lds
    buffer_load_dwordx4 v9, s[28:31], s47 offen offset:3072  lds
    s_waitcnt vmcnt(6)
    s_barrier
    ds_read_b64_tr_b16 v[40:41], v240 offset:0
    ds_read_b64_tr_b16 v[42:43], v240 offset:4096
    ds_read_b64_tr_b16 v[44:45], v241 offset:0
    ds_read_b64_tr_b16 v[46:47], v241 offset:4096
    ds_read_b64_tr_b16 v[48:49], v240 offset:8192
    ds_read_b64_tr_b16 v[50:51], v240 offset:12288
    ds_read_b64_tr_b16 v[52:53], v241 offset:8192
    ds_read_b64_tr_b16 v[54:55], v241 offset:12288
    ds_read_b64_tr_b16 v[56:57], v240 offset:1024
    ds_read_b64_tr_b16 v[58:59], v240 offset:5120
    ds_read_b64_tr_b16 v[60:61], v241 offset:1024
    ds_read_b64_tr_b16 v[62:63], v241 offset:5120
    ds_read_b64_tr_b16 v[64:65], v240 offset:9216
    ds_read_b64_tr_b16 v[66:67], v240 offset:13312
    ds_read_b64_tr_b16 v[68:69], v241 offset:9216
    ds_read_b64_tr_b16 v[70:71], v241 offset:13312
    s_waitcnt lgkmcnt(14)
    v_mfma_f32_16x16x32_f16 v[72:75], v[40:43], v[176:179], 0
    buffer_store_dwordx4 a[224:227], v245, s[12:15], s8 offen sc1
    v_mfma_f32_16x16x32_f16 v[76:79], v[40:43], v[192:195], 0
    s_waitcnt lgkmcnt(12)
    v_mfma_f32_16x16x32_f16 v[72:75], v[44:47], v[184:187], v[72:75]
    buffer_store_dwordx4 a[228:231], v245, s[12:15], s9 offen sc1
    v_mfma_f32_16x16x32_f16 v[76:79], v[44:47], v[176:179], v[76:79]
    ds_read_b32 v32, v251 offset:32
    ds_read_b32 v33, v251 offset:512
    s_waitcnt lgkmcnt(12)
    v_mfma_f32_16x16x32_f16 v[72:75], v[48:51], v[180:183], v[72:75]
    ds_read_b32 v34, v251 offset:160
    ds_read_b32 v35, v251 offset:640
    v_mfma_f32_16x16x32_f16 v[76:79], v[48:51], v[196:199], v[76:79]
    ds_read_b32 v36, v251 offset:8224
    ds_read_b32 v37, v251 offset:8704
    s_waitcnt lgkmcnt(14)
    v_mfma_f32_16x16x32_f16 v[72:75], v[52:55], v[188:191], v[72:75]
    ds_read_b32 v38, v251 offset:8352
    ds_read_b32 v39, v251 offset:8832
    v_mfma_f32_16x16x32_f16 v[76:79], v[52:55], v[180:183], v[76:79]
    ds_read_b128 v[16:19], v252
    ds_read_b128 v[20:23], v242
    s_waitcnt lgkmcnt(15)
    v_mfma_f32_16x16x32_f16 v[80:83], v[56:59], v[176:179], 0
    buffer_store_dwordx4 a[232:235], v245, s[12:15], s10 offen sc1
    v_mfma_f32_16x16x32_f16 v[84:87], v[56:59], v[192:195], 0
    s_waitcnt lgkmcnt(14)
    v_mfma_f32_16x16x32_f16 v[80:83], v[60:63], v[184:187], v[80:83]
    v_pk_mul_f32 v[88:89], v[72:73], v[224:225]
    v_pk_mul_f32 v[92:93], v[76:77], v[224:225]
    v_mfma_f32_16x16x32_f16 v[84:87], v[60:63], v[176:179], v[84:87]
    v_pk_mul_f32 v[90:91], v[74:75], v[226:227]
    v_pk_mul_f32 v[94:95], v[78:79], v[226:227]
    s_waitcnt lgkmcnt(12)
    v_mfma_f32_16x16x32_f16 v[80:83], v[64:67], v[180:183], v[80:83]
    v_pk_fma_f32 v[88:89], v[76:77], v[232:233], v[88:89]
    v_pk_fma_f32 v[92:93], v[72:73], v[232:233], v[92:93] neg_lo:[1,0,0] neg_hi:[1,0,0]
    v_mfma_f32_16x16x32_f16 v[84:87], v[64:67], v[196:199], v[84:87]
    v_pk_fma_f32 v[90:91], v[78:79], v[234:235], v[90:91]
    v_pk_fma_f32 v[94:95], v[74:75], v[234:235], v[94:95] neg_lo:[1,0,0] neg_hi:[1,0,0]
    s_waitcnt lgkmcnt(10)
    v_mfma_f32_16x16x32_f16 v[80:83], v[68:71], v[188:191], v[80:83]
    v_cvt_pk_f16_f32 v120, v88, v89
    v_cvt_pk_f16_f32 v121, v90, v91
    v_mfma_f32_16x16x32_f16 v[84:87], v[68:71], v[180:183], v[84:87]
    v_cvt_pk_f16_f32 v124, v92, v93
    v_cvt_pk_f16_f32 v125, v94, v95
    buffer_store_dwordx4 a[236:239], v245, s[12:15], s11 offen sc1
    s_waitcnt lgkmcnt(9)
    v_lshlrev_b32 v104, 16, v32
    v_and_b32 v112, 0xffff0000, v32
    s_waitcnt lgkmcnt(8)
    v_lshlrev_b32 v105, 16, v33
    v_and_b32 v113, 0xffff0000, v33
    s_waitcnt lgkmcnt(7)
    v_lshlrev_b32 v106, 16, v34
    v_and_b32 v114, 0xffff0000, v34
    v_pk_mul_f32 v[96:97], v[80:81], v[228:229]
    v_pk_mul_f32 v[100:101], v[84:85], v[228:229]
    v_pk_mul_f32 v[98:99], v[82:83], v[230:231]
    v_pk_mul_f32 v[102:103], v[86:87], v[230:231]
    v_pk_fma_f32 v[96:97], v[84:85], v[236:237], v[96:97]
    v_pk_fma_f32 v[100:101], v[80:81], v[236:237], v[100:101] neg_lo:[1,0,0] neg_hi:[1,0,0]
    v_pk_fma_f32 v[98:99], v[86:87], v[238:239], v[98:99]
    v_pk_fma_f32 v[102:103], v[82:83], v[238:239], v[102:103] neg_lo:[1,0,0] neg_hi:[1,0,0]
    v_cvt_pk_f16_f32 v122, v96, v97
    v_cvt_pk_f16_f32 v123, v98, v99
    v_cvt_pk_f16_f32 v126, v100, v101
    v_cvt_pk_f16_f32 v127, v102, v103
    v_mfma_f32_16x16x32_f16 v[72:75], v[128:131], v[120:123], 0
    s_lshl_b32 s47, s48, 4
    s_add_u32 s47, s47, 32768
    s_add_u32 m0, s99, 4096
    s_nop 0
    buffer_load_dwordx4 v6, s[28:31], s47 offen offset:0  lds
    v_mfma_f32_16x16x32_f16 v[76:79], v[144:147], v[120:123], 0
    s_waitcnt lgkmcnt(6)
    v_lshlrev_b32 v107, 16, v35
    v_and_b32 v115, 0xffff0000, v35
    v_mfma_f32_16x16x32_f16 v[72:75], v[136:139], v[124:127], v[72:75]
    s_waitcnt lgkmcnt(5)
    v_lshlrev_b32 v108, 16, v36
    v_and_b32 v116, 0xffff0000, v36
    v_mfma_f32_16x16x32_f16 v[76:79], v[128:131], v[124:127], v[76:79]
    s_waitcnt lgkmcnt(4)
    v_lshlrev_b32 v109, 16, v37
    v_and_b32 v117, 0xffff0000, v37
    v_mfma_f32_16x16x32_f16 v[80:83], v[132:135], v[120:123], 0
    s_waitcnt lgkmcnt(3)
    v_lshlrev_b32 v110, 16, v38
    v_and_b32 v118, 0xffff0000, v38
    v_mfma_f32_16x16x32_f16 v[84:87], v[148:151], v[120:123], 0
    s_waitcnt lgkmcnt(2)
    v_lshlrev_b32 v111, 16, v39
    v_and_b32 v119, 0xffff0000, v39
    v_mfma_f32_16x16x32_f16 v[80:83], v[140:143], v[124:127], v[80:83]
    buffer_load_dwordx4 v7, s[28:31], s47 offen offset:1024  lds
    v_mfma_f32_16x16x32_f16 v[84:87], v[132:135], v[124:127], v[84:87]
    v_pk_mul_f32 v[88:89], v[72:73], v[104:105]
    v_pk_mul_f32 v[92:93], v[76:77], v[104:105]
    v_pk_mul_f32 v[90:91], v[74:75], v[106:107]
    v_pk_mul_f32 v[94:95], v[78:79], v[106:107]
    v_pk_fma_f32 v[88:89], v[76:77], v[112:113], v[88:89] neg_lo:[1,0,0] neg_hi:[1,0,0]
    v_pk_fma_f32 v[92:93], v[72:73], v[112:113], v[92:93]
    v_pk_fma_f32 v[90:91], v[78:79], v[114:115], v[90:91] neg_lo:[1,0,0] neg_hi:[1,0,0]
    v_pk_fma_f32 v[94:95], v[74:75], v[114:115], v[94:95]
    v_cvt_pk_bf16_f32 v40, v88, v89
    v_cvt_pk_bf16_f32 v41, v90, v91
    v_cvt_pk_bf16_f32 v44, v92, v93
    v_cvt_pk_bf16_f32 v45, v94, v95
    v_pk_mul_f32 v[96:97], v[80:81], v[108:109]
    v_pk_mul_f32 v[100:101], v[84:85], v[108:109]
    v_pk_mul_f32 v[98:99], v[82:83], v[110:111]
    v_pk_mul_f32 v[102:103], v[86:87], v[110:111]
    v_pk_fma_f32 v[96:97], v[84:85], v[116:117], v[96:97] neg_lo:[1,0,0] neg_hi:[1,0,0]
    v_pk_fma_f32 v[100:101], v[80:81], v[116:117], v[100:101]
    v_pk_fma_f32 v[98:99], v[86:87], v[118:119], v[98:99] neg_lo:[1,0,0] neg_hi:[1,0,0]
    v_pk_fma_f32 v[102:103], v[82:83], v[118:119], v[102:103]
    v_cvt_pk_bf16_f32 v42, v96, v97
    v_cvt_pk_bf16_f32 v43, v98, v99
    v_cvt_pk_bf16_f32 v46, v100, v101
    v_cvt_pk_bf16_f32 v47, v102, v103
    v_mfma_f32_16x16x32_bf16 v[72:75], v[152:155], v[40:43], 0
    s_waitcnt vmcnt(10)
    ds_read_b128 v[24:27], v244 offset:24576
    v_mfma_f32_16x16x32_bf16 v[76:79], v[160:163], v[40:43], 0
    ds_read_b128 v[28:31], v244 offset:24592
    v_mfma_f32_16x16x32_bf16 v[72:75], v[168:171], v[44:47], v[72:75]
    buffer_load_dwordx4 v8, s[28:31], s47 offen offset:2048  lds
    v_mfma_f32_16x16x32_bf16 v[76:79], v[152:155], v[44:47], v[76:79]
    v_mfma_f32_16x16x32_bf16 v[80:83], v[156:159], v[40:43], 0
    v_mfma_f32_16x16x32_bf16 v[84:87], v[164:167], v[40:43], 0
    buffer_load_dwordx4 v9, s[28:31], s47 offen offset:3072  lds
    v_mfma_f32_16x16x32_bf16 v[80:83], v[172:175], v[44:47], v[80:83]
    v_mfma_f32_16x16x32_bf16 v[84:87], v[156:159], v[44:47], v[84:87]
    s_nop 0
    v_pk_mul_f32 v[88:89], v[72:73], v[224:225]
    s_nop 0
    v_pk_mul_f32 v[92:93], v[76:77], v[224:225]
    v_pk_mul_f32 v[90:91], v[74:75], v[226:227]
    v_pk_mul_f32 v[94:95], v[78:79], v[226:227]
    v_pk_fma_f32 v[88:89], v[76:77], v[232:233], v[88:89] neg_lo:[1,0,0] neg_hi:[1,0,0]
    v_pk_fma_f32 v[92:93], v[72:73], v[232:233], v[92:93]
    v_pk_fma_f32 v[90:91], v[78:79], v[234:235], v[90:91] neg_lo:[1,0,0] neg_hi:[1,0,0]
    v_pk_fma_f32 v[94:95], v[74:75], v[234:235], v[94:95]
    v_cvt_pk_bf16_f32 v120, v88, v89
    v_cvt_pk_bf16_f32 v121, v90, v91
    v_cvt_pk_bf16_f32 v124, v92, v93
    v_cvt_pk_bf16_f32 v125, v94, v95
    ds_write_b64 v254, v[120:121] offset:16384
    ds_write_b64 v254, v[124:125] offset:20480
    v_pk_mul_f32 v[96:97], v[80:81], v[228:229]
    v_pk_mul_f32 v[100:101], v[84:85], v[228:229]
    v_pk_mul_f32 v[98:99], v[82:83], v[230:231]
    v_pk_mul_f32 v[102:103], v[86:87], v[230:231]
    v_pk_fma_f32 v[96:97], v[84:85], v[236:237], v[96:97] neg_lo:[1,0,0] neg_hi:[1,0,0]
    v_pk_fma_f32 v[100:101], v[80:81], v[236:237], v[100:101]
    v_pk_fma_f32 v[98:99], v[86:87], v[238:239], v[98:99] neg_lo:[1,0,0] neg_hi:[1,0,0]
    v_pk_fma_f32 v[102:103], v[82:83], v[238:239], v[102:103]
    v_cvt_pk_bf16_f32 v122, v96, v97
    v_cvt_pk_bf16_f32 v123, v98, v99
    v_cvt_pk_bf16_f32 v126, v100, v101
    v_cvt_pk_bf16_f32 v127, v102, v103
    ds_write_b64 v254, v[122:123] offset:16400
    ds_write_b64 v254, v[126:127] offset:20496
    s_lshl_b32 s47, s49, 4
    s_add_u32 m0, s99, 8192
    s_nop 0
    buffer_load_dwordx4 v6, s[28:31], s47 offen offset:0  lds
    buffer_load_dwordx4 v7, s[28:31], s47 offen offset:1024  lds
    s_waitcnt vmcnt(6)
    s_waitcnt lgkmcnt(0)
    s_barrier
    buffer_store_dword v13, v15, s[12:15], s40 offen sc1
    ds_read_b64_tr_b16 v[40:41], v253 offset:16384
    ds_read_b64_tr_b16 v[42:43], v253 offset:16896
    ds_read_b64_tr_b16 v[44:45], v253 offset:20480
    ds_read_b64_tr_b16 v[46:47], v253 offset:20992
    ds_read_b64_tr_b16 v[48:49], v253 offset:17408
    ds_read_b64_tr_b16 v[50:51], v253 offset:17920
    ds_read_b64_tr_b16 v[52:53], v253 offset:21504
    ds_read_b64_tr_b16 v[54:55], v253 offset:22016
    ds_read_b64_tr_b16 v[56:57], v253 offset:18432
    ds_read_b64_tr_b16 v[58:59], v253 offset:18944
    ds_read_b64_tr_b16 v[60:61], v253 offset:22528
    ds_read_b64_tr_b16 v[62:63], v253 offset:23040
    ds_read_b64_tr_b16 v[64:65], v253 offset:19456
    ds_read_b64_tr_b16 v[66:67], v253 offset:19968
    ds_read_b64_tr_b16 v[68:69], v253 offset:23552
    ds_read_b64_tr_b16 v[70:71], v253 offset:24064
    s_waitcnt lgkmcnt(14)
    v_mfma_f32_16x16x32_bf16 v[72:75], v[40:43], v[200:203], 0
    buffer_load_dwordx4 v8, s[28:31], s47 offen offset:2048  lds
    v_mfma_f32_16x16x32_bf16 v[76:79], v[40:43], v[208:211], 0
    buffer_load_dwordx4 v9, s[28:31], s47 offen offset:3072  lds
    s_waitcnt lgkmcnt(12)
    v_mfma_f32_16x16x32_bf16 v[72:75], v[44:47], v[216:219], v[72:75]
    s_lshl_b32 s47, s49, 4
    s_add_u32 s47, s47, 32768
    s_add_u32 m0, s99, 12288
    s_nop 0
    buffer_load_dwordx4 v6, s[28:31], s47 offen offset:0  lds
    v_mfma_f32_16x16x32_bf16 v[76:79], v[44:47], v[200:203], v[76:79]
    buffer_load_dwordx4 v7, s[28:31], s47 offen offset:1024  lds
    s_waitcnt lgkmcnt(10)
    v_mfma_f32_16x16x32_bf16 v[72:75], v[48:51], v[204:207], v[72:75]
    buffer_load_dwordx4 v8, s[28:31], s47 offen offset:2048  lds
    v_mfma_f32_16x16x32_bf16 v[76:79], v[48:51], v[212:215], v[76:79]
    s_waitcnt lgkmcnt(8)
    v_mfma_f32_16x16x32_bf16 v[72:75], v[52:55], v[220:223], v[72:75]
    buffer_load_dwordx4 v9, s[28:31], s47 offen offset:3072  lds
    v_mfma_f32_16x16x32_bf16 v[76:79], v[52:55], v[204:207], v[76:79]
    s_waitcnt lgkmcnt(6)
    v_mfma_f32_16x16x32_bf16 v[80:83], v[56:59], v[200:203], 0
    v_mfma_f32_16x16x32_bf16 v[84:87], v[56:59], v[208:211], 0
    s_waitcnt lgkmcnt(4)
    v_mfma_f32_16x16x32_bf16 v[80:83], v[60:63], v[216:219], v[80:83]
    s_nop 0
    v_fma_mix_f32 v88, v16, v24, v72 op_sel:[0,0,0] op_sel_hi:[1,0,0]
    v_fma_mix_f32 v89, v16, v25, v73 op_sel:[1,0,0] op_sel_hi:[1,0,0]
    v_mfma_f32_16x16x32_bf16 v[84:87], v[60:63], v[200:203], v[84:87]
    v_fma_mix_f32 v90, v17, v26, v74 op_sel:[0,0,0] op_sel_hi:[1,0,0]
    v_fma_mix_f32 v91, v17, v27, v75 op_sel:[1,0,0] op_sel_hi:[1,0,0]
    s_waitcnt lgkmcnt(2)
    v_mfma_f32_16x16x32_bf16 v[80:83], v[64:67], v[204:207], v[80:83]
    v_cvt_pk_bf16_f32 v120, v88, v89
    v_cvt_pk_bf16_f32 v121, v90, v91
    v_mfma_f32_16x16x32_bf16 v[84:87], v[64:67], v[212:215], v[84:87]
    v_fma_mix_f32 v96, v20, v24, v76 op_sel:[0,0,0] op_sel_hi:[1,0,0]
    v_fma_mix_f32 v97, v20, v25, v77 op_sel:[1,0,0] op_sel_hi:[1,0,0]
    s_waitcnt lgkmcnt(0)
    v_mfma_f32_16x16x32_bf16 v[80:83], v[68:71], v[220:223], v[80:83]
    v_fma_mix_f32 v98, v21, v26, v78 op_sel:[0,0,0] op_sel_hi:[1,0,0]
    v_fma_mix_f32 v99, v21, v27, v79 op_sel:[1,0,0] op_sel_hi:[1,0,0]
    v_mfma_f32_16x16x32_bf16 v[84:87], v[68:71], v[204:207], v[84:87]
    v_cvt_pk_bf16_f32 v124, v96, v97
    v_cvt_pk_bf16_f32 v125, v98, v99
    v_and_b32 v124, s22, v124
    v_and_b32 v125, s22, v125
    s_nop 0
    v_fma_mix_f32 v92, v18, v28, v80 op_sel:[0,0,0] op_sel_hi:[1,0,0]
    v_fma_mix_f32 v93, v18, v29, v81 op_sel:[1,0,0] op_sel_hi:[1,0,0]
    v_fma_mix_f32 v94, v19, v30, v82 op_sel:[0,0,0] op_sel_hi:[1,0,0]
    v_fma_mix_f32 v95, v19, v31, v83 op_sel:[1,0,0] op_sel_hi:[1,0,0]
    v_cvt_pk_bf16_f32 v122, v92, v93
    v_cvt_pk_bf16_f32 v123, v94, v95
    buffer_store_dwordx4 v[120:123], v255, s[12:15], s20 offen sc1
    v_fma_mix_f32 v100, v22, v28, v84 op_sel:[0,0,0] op_sel_hi:[1,0,0]
    v_fma_mix_f32 v101, v22, v29, v85 op_sel:[1,0,0] op_sel_hi:[1,0,0]
    v_fma_mix_f32 v102, v23, v30, v86 op_sel:[0,0,0] op_sel_hi:[1,0,0]
    v_fma_mix_f32 v103, v23, v31, v87 op_sel:[1,0,0] op_sel_hi:[1,0,0]
    v_cvt_pk_bf16_f32 v126, v100, v101
    v_cvt_pk_bf16_f32 v127, v102, v103
    v_and_b32 v126, s22, v126
    v_and_b32 v127, s22, v127
    buffer_store_dwordx4 v[124:127], v255, s[12:15], s21 offen sc1
    v_mov_b32 v200, v1
    v_mov_b32 v201, v4
    v_mov_b32 v233, v11
    s_waitcnt vmcnt(2)
    v_bfe_u32 v202, v200, 2, 2
    v_mul_u32_u24 v204, 4352, v202
    v_lshrrev_b32 v203, 4, v200
    v_lshl_add_u32 v204, v203, 6, v204
    v_and_b32 v203, 3, v200
    v_lshl_add_u32 v204, v203, 4, v204
    v_add_u32 v205, 16384, v204
    v_add_u32 v206, 32768, v204
    v_add_u32 v207, 49152, v204
    s_lshl_b32 s8, s4, 8
    s_add_u32 s8, s8, 0x490000
    s_lshl_b32 s10, s5, 2
    s_add_u32 s10, s10, s3
    s_mul_i32 s10, s10, 34816
    s_add_u32 s10, s10, s8
    s_add_u32 s11, s57, 131072
    s_mul_i32 s9, s3, 69632
    s_add_u32 s8, s8, s9
    s_lshl_b32 s9, s3, 12
    s_mov_b32 s16, s8
    s_mov_b32 s17, s9
    v_mov_b32 v250, v6
    v_mov_b32 v251, v7
    v_mov_b32 v252, v8
    v_mov_b32 v253, v9
    s_mul_i32 s99, s3, 20480
    v_add_u32 v249, s99, v10
    s_lshl_b32 s35, s3, 12
    s_add_u32 s35, s35, 139776
    v_add_u32 v254, s35, v10
    ds_read_b64_tr_b16 a[0:1], v248 offset:0
    ds_read_b64_tr_b16 a[2:3], v248 offset:512
    ds_read_b64_tr_b16 a[4:5], v248 offset:256
    ds_read_b64_tr_b16 a[6:7], v248 offset:768
    ds_read_b64_tr_b16 a[8:9], v248 offset:2048
    ds_read_b64_tr_b16 a[10:11], v248 offset:2560
    ds_read_b64_tr_b16 a[12:13], v248 offset:2304
    ds_read_b64_tr_b16 a[14:15], v248 offset:2816
    ds_read_b64_tr_b16 a[16:17], v248 offset:4096
    ds_read_b64_tr_b16 a[18:19], v248 offset:4608
    ds_read_b64_tr_b16 a[20:21], v248 offset:4352
    ds_read_b64_tr_b16 a[22:23], v248 offset:4864
    ds_read_b64_tr_b16 a[24:25], v248 offset:6144
    ds_read_b64_tr_b16 a[26:27], v248 offset:6656
    ds_read_b64_tr_b16 a[28:29], v248 offset:6400
    ds_read_b64_tr_b16 a[30:31], v248 offset:6912
    ds_read_b64_tr_b16 a[32:33], v248 offset:8192
    ds_read_b64_tr_b16 a[34:35], v248 offset:8704
    ds_read_b64_tr_b16 a[36:37], v248 offset:8448
    ds_read_b64_tr_b16 a[38:39], v248 offset:8960
    ds_read_b64_tr_b16 a[40:41], v248 offset:10240
    ds_read_b64_tr_b16 a[42:43], v248 offset:10752
    ds_read_b64_tr_b16 a[44:45], v248 offset:10496
    ds_read_b64_tr_b16 a[46:47], v248 offset:11008
    ds_read_b64_tr_b16 a[48:49], v248 offset:12288
    ds_read_b64_tr_b16 a[50:51], v248 offset:12800
    ds_read_b64_tr_b16 a[52:53], v248 offset:12544
    ds_read_b64_tr_b16 a[54:55], v248 offset:13056
    ds_read_b64_tr_b16 a[56:57], v248 offset:14336
    ds_read_b64_tr_b16 a[58:59], v248 offset:14848
    ds_read_b64_tr_b16 a[60:61], v248 offset:14592
    ds_read_b64_tr_b16 a[62:63], v248 offset:15104
    ds_read_b64_tr_b16 a[64:65], v248 offset:16384
    ds_read_b64_tr_b16 a[66:67], v248 offset:16896
    ds_read_b64_tr_b16 a[68:69], v248 offset:16640
    ds_read_b64_tr_b16 a[70:71], v248 offset:17152
    ds_read_b64_tr_b16 a[72:73], v248 offset:18432
    ds_read_b64_tr_b16 a[74:75], v248 offset:18944
    ds_read_b64_tr_b16 a[76:77], v248 offset:18688
    ds_read_b64_tr_b16 a[78:79], v248 offset:19200
    ds_read_b64_tr_b16 a[80:81], v248 offset:20480
    ds_read_b64_tr_b16 a[82:83], v248 offset:20992
    ds_read_b64_tr_b16 a[84:85], v248 offset:20736
    ds_read_b64_tr_b16 a[86:87], v248 offset:21248
    ds_read_b64_tr_b16 a[88:89], v248 offset:22528
    ds_read_b64_tr_b16 a[90:91], v248 offset:23040
    ds_read_b64_tr_b16 a[92:93], v248 offset:22784
    ds_read_b64_tr_b16 a[94:95], v248 offset:23296
    ds_read_b64_tr_b16 a[96:97], v248 offset:24576
    ds_read_b64_tr_b16 a[98:99], v248 offset:25088
    ds_read_b64_tr_b16 a[100:101], v248 offset:24832
    ds_read_b64_tr_b16 a[102:103], v248 offset:25344
    ds_read_b64_tr_b16 a[104:105], v248 offset:26624
    ds_read_b64_tr_b16 a[106:107], v248 offset:27136
    ds_read_b64_tr_b16 a[108:109], v248 offset:26880
    ds_read_b64_tr_b16 a[110:111], v248 offset:27392
    ds_read_b64_tr_b16 a[112:113], v248 offset:28672
    ds_read_b64_tr_b16 a[114:115], v248 offset:29184
    ds_read_b64_tr_b16 a[116:117], v248 offset:28928
    ds_read_b64_tr_b16 a[118:119], v248 offset:29440
    ds_read_b64_tr_b16 a[120:121], v248 offset:30720
    ds_read_b64_tr_b16 a[122:123], v248 offset:31232
    ds_read_b64_tr_b16 a[124:125], v248 offset:30976
    ds_read_b64_tr_b16 a[126:127], v248 offset:31488
    s_mov_b32 exec_lo, 0xffff
    s_mov_b32 exec_hi, 0x0
    buffer_load_dword v12, v11, s[12:15], s23 offen sc1
    s_mov_b64 exec, -1
    s_barrier
    s_mov_b32 m0, s9
    s_add_u32 s9, s9, 16384
    buffer_load_dwordx4 v204, s[12:15], s8 offen offset:0 sc1 lds
    buffer_load_dwordx4 v205, s[12:15], s8 offen offset:1024 sc1 lds
    buffer_load_dwordx4 v206, s[12:15], s8 offen offset:2048 sc1 lds
    buffer_load_dwordx4 v207, s[12:15], s8 offen offset:3072 sc1 lds
    s_add_u32 s8, s8, 278528
    s_mov_b32 m0, s9
    s_add_u32 s9, s9, 16384
    buffer_load_dwordx4 v204, s[12:15], s8 offen offset:0 sc1 lds
    buffer_load_dwordx4 v205, s[12:15], s8 offen offset:1024 sc1 lds
    buffer_load_dwordx4 v206, s[12:15], s8 offen offset:2048 sc1 lds
    buffer_load_dwordx4 v207, s[12:15], s8 offen offset:3072 sc1 lds
    s_add_u32 s8, s8, 278528
    v_lshrrev_b32 v202, 5, v200
    v_lshlrev_b32 v208, 11, v202
    v_bfe_u32 v203, v200, 2, 2
    v_lshl_add_u32 v208, v203, 6, v208
    v_bfe_u32 v203, v200, 4, 1
    v_lshl_add_u32 v208, v203, 5, v208
    v_and_b32 v203, 3, v200
    v_lshl_add_u32 v208, v203, 3, v208
    v_add_u32 v209, 0x10000, v208
    s_lshl_b32 s44, s3, 8
    s_add_u32 s44, s44, 131072
    v_add_u32 v210, s44, v208
    v_and_b32 v203, 31, v200
    v_lshlrev_b32 v232, 2, v203
    v_lshrrev_b32 v202, 3, v200
    v_lshlrev_b32 v235, 9, v202
    v_and_b32 v202, 7, v200
    v_lshl_add_u32 v235, v202, 4, v235
    v_lshlrev_b32 v236, 4, v202
    v_bfe_u32 v202, v200, 4, 1
    v_lshl_add_u32 v236, v202, 3, v236
    v_lshrrev_b32 v202, 5, v200
    v_lshl_add_u32 v236, v202, 2, v236
    s_lshl_b32 s44, s3, 7
    s_add_u32 s45, s44, 139264
    v_add_u32 v236, s45, v236
    s_lshl_b32 s40, s4, 13
    s_add_u32 s40, s40, s44
    s_add_u32 s40, s40, 0x420000
    s_lshl_b32 s41, s5, 9
    s_add_u32 s41, s41, s40
    s_add_u32 s56, s40, 4096
    s_lshr_b32 s44, s6, 1
    s_lshl_b32 s98, s44, 12
    s_lshl_b32 s44, s44, 2
    s_and_b32 s45, s6, 1
    s_add_u32 s6, s44, s45
    s_mul_i32 s46, s6, 112
    s_mul_i32 s45, s3, 28
    s_add_u32 s46, s46, s45
    s_lshl_b32 s46, s46, 10
    s_add_u32 s46, s46, 0xcc0000
    v_add_u32 v237, s46, v201
    v_add_u32 v238, 229376, v237
    s_add_u32 s59, s98, 0x450000
    s_add_u32 s98, s98, 0x460000
    s_lshl_b32 s96, s4, 4
    s_add_u32 s96, s96, s5
    s_lshl_b32 s96, s96, 8
    s_add_u32 s97, s96, 0x450000
    s_add_u32 s96, s96, 0x460000
    s_lshl_b32 s55, s6, 15
    s_lshl_b32 s44, s7, 12
    s_add_u32 s55, s55, s44
    s_and_b32 s44, s3, 1
    s_lshl_b32 s44, s44, 11
    s_add_u32 s55, s55, s44
    s_add_u32 s55, s55, 0x6c0000
    s_add_u32 s57, s55, 65536
    s_cmp_lt_u32 s3, 2
    s_cselect_b32 s55, s55, 0x7ff00000
    s_cselect_b32 s57, 0x7ff00000, s57
    v_mov_b32 v239, 1
    v_mov_b32 v240, 0x7ff00000
    v_cmp_eq_u32 vcc, 0, v0
    v_add_u32 v241, s17, v201
    v_add_u32 v242, 0x10000, v241
    v_add_u32 v243, s11, v201
    s_mov_b32 s19, 0
    v_cndmask_b32 v240, v240, 0, vcc
    s_waitcnt lgkmcnt(0)
    s_waitcnt vmcnt(8)
    s_mov_b32 exec_lo, 0xffff
    s_mov_b32 exec_hi, 0x0
    v_cmp_gt_u32 vcc, 1, v12
    s_mov_b64 exec, -1
    s_nop 3
    s_cbranch_vccz p_fbok
    s_mov_b32 s58, 0
    s_mov_b32 exec_lo, 0xffff
    s_mov_b32 exec_hi, 0x0
p_pollb:
    buffer_load_dword v12, v11, s[12:15], s23 offen sc1
    s_add_u32 s58, s58, 1
    s_cmp_ge_u32 s58, 32768
    s_cbranch_scc1 p_pollb_out
    s_waitcnt vmcnt(0)
    v_cmp_gt_u32 vcc, 1, v12
    s_nop 4
    s_cbranch_vccnz p_pollb
p_pollb_out:
    s_waitcnt vmcnt(0)
    s_mov_b64 exec, -1
p_fbok:
    buffer_load_dwordx4 a[160:163], v246, s[12:15], 0 offen offset:0 sc1
    buffer_load_dwordx4 a[164:167], v247, s[12:15], 0 offen offset:0 sc1
    buffer_load_dwordx4 a[168:171], v246, s[12:15], 0 offen offset:1024 sc1
    buffer_load_dwordx4 a[172:175], v247, s[12:15], 0 offen offset:1024 sc1
    buffer_load_dwordx4 a[176:179], v246, s[12:15], 0 offen offset:2048 sc1
    buffer_load_dwordx4 a[180:183], v247, s[12:15], 0 offen offset:2048 sc1
    buffer_load_dwordx4 a[184:187], v246, s[12:15], 0 offen offset:3072 sc1
    buffer_load_dwordx4 a[188:191], v247, s[12:15], 0 offen offset:3072 sc1
    buffer_load_dwordx4 a[192:195], v246, s[12:15], s24 offen offset:0 sc1
    buffer_load_dwordx4 a[196:199], v247, s[12:15], s24 offen offset:0 sc1
    buffer_load_dwordx4 a[200:203], v246, s[12:15], s24 offen offset:1024 sc1
    buffer_load_dwordx4 a[204:207], v247, s[12:15], s24 offen offset:1024 sc1
    buffer_load_dwordx4 a[208:211], v246, s[12:15], s24 offen offset:2048 sc1
    buffer_load_dwordx4 a[212:215], v247, s[12:15], s24 offen offset:2048 sc1
    buffer_load_dwordx4 a[216:219], v246, s[12:15], s24 offen offset:3072 sc1
    buffer_load_dwordx4 a[220:223], v247, s[12:15], s24 offen offset:3072 sc1
    s_waitcnt lgkmcnt(0)
    s_cmp_ge_u32 s5, 14
    s_cbranch_scc1 p_hpath
    s_lshl_b32 s43, s5, 2
    s_add_u32 s43, s43, s3
    s_lshl_b32 s43, s43, 1
    s_mul_i32 s44, s4, 448
    s_add_u32 s43, s43, s44
    s_lshl_b32 s43, s43, 10
    s_add_u32 s43, s43, 0xcc0000
    s_add_u32 s44, s43, 114688
    s_add_u32 s45, s43, 229376
    s_add_u32 s46, s43, 344064
    s_waitcnt vmcnt(20)
    ds_read2st64_b32 v[220:221], v241 offset0:0 offset1:4
    ds_read2st64_b32 v[222:223], v241 offset0:8 offset1:12
    s_waitcnt lgkmcnt(0)
    v_max3_u32 v220, v220, v221, v222
    v_max_u32 v220, v220, v223
    v_cmp_eq_u32 vcc, -1, v220
    s_nop 4
    s_cbranch_vccnz p_vg0
p_wg0:
    s_barrier
    ds_read_b64_tr_b16 v[128:129], v208 offset:0
    ds_read_b64_tr_b16 v[130:131], v208 offset:1024
    ds_read_b64_tr_b16 v[132:133], v208 offset:256
    ds_read_b64_tr_b16 v[134:135], v208 offset:1280
    ds_read_b64_tr_b16 v[136:137], v208 offset:512
    ds_read_b64_tr_b16 v[138:139], v208 offset:1536
    ds_read_b64_tr_b16 v[140:141], v208 offset:768
    ds_read_b64_tr_b16 v[142:143], v208 offset:1792
    ds_read_b64_tr_b16 v[144:145], v208 offset:4096
    ds_read_b64_tr_b16 v[146:147], v208 offset:5120
    ds_read_b64_tr_b16 v[148:149], v208 offset:4352
    ds_read_b64_tr_b16 v[150:151], v208 offset:5376
    ds_read_b64_tr_b16 v[152:153], v208 offset:4608
    ds_read_b64_tr_b16 v[154:155], v208 offset:5632
    s_mov_b32 m0, s11
    s_nop 0
    buffer_load_dwordx4 v204, s[12:15], s10 offen offset:0 sc1 lds
    buffer_load_dwordx4 v205, s[12:15], s10 offen offset:1024 sc1 lds
    s_waitcnt lgkmcnt(12)
    s_waitcnt vmcnt(17)
    v_mfma_f32_32x32x16_bf16 v[0:15], a[160:163], v[128:131], 0
    ds_read_b64_tr_b16 v[156:157], v208 offset:4864
    s_waitcnt vmcnt(16)
    v_mfma_f32_32x32x16_bf16 v[64:79], a[164:167], v[128:131], 0
    ds_read_b64_tr_b16 v[158:159], v208 offset:5888
    s_waitcnt lgkmcnt(12)
    v_mfma_f32_32x32x16_bf16 v[16:31], a[160:163], v[132:135], 0
    ds_read_b64_tr_b16 v[160:161], v208 offset:8192
    v_mfma_f32_32x32x16_bf16 v[80:95], a[164:167], v[132:135], 0
    ds_read_b64_tr_b16 v[162:163], v208 offset:9216
    s_mov_b32 m0, s9
    s_add_u32 s9, s9, 16384
    buffer_load_dwordx4 v204, s[12:15], s8 offen offset:0 sc1 lds
    s_waitcnt lgkmcnt(12)
    v_mfma_f32_32x32x16_bf16 v[32:47], a[160:163], v[136:139], 0
    ds_read_b64_tr_b16 v[164:165], v208 offset:8448
    v_mfma_f32_32x32x16_bf16 v[96:111], a[164:167], v[136:139], 0
    ds_read_b64_tr_b16 v[166:167], v208 offset:9472
    buffer_load_dwordx4 v205, s[12:15], s8 offen offset:1024 sc1 lds
    s_waitcnt lgkmcnt(12)
    v_mfma_f32_32x32x16_bf16 v[48:63], a[160:163], v[140:143], 0
    ds_read_b64_tr_b16 v[128:129], v208 offset:8704
    v_mfma_f32_32x32x16_bf16 v[112:127], a[164:167], v[140:143], 0
    ds_read_b64_tr_b16 v[130:131], v208 offset:9728
    buffer_load_dwordx4 v206, s[12:15], s8 offen offset:2048 sc1 lds
    s_waitcnt lgkmcnt(12)
    s_waitcnt vmcnt(18)
    v_mfma_f32_32x32x16_bf16 v[0:15], a[168:171], v[144:147], v[0:15]
    ds_read_b64_tr_b16 v[132:133], v208 offset:8960
    s_waitcnt vmcnt(17)
    v_mfma_f32_32x32x16_bf16 v[64:79], a[172:175], v[144:147], v[64:79]
    ds_read_b64_tr_b16 v[134:135], v208 offset:9984
    buffer_load_dwordx4 v207, s[12:15], s8 offen offset:3072 sc1 lds
    s_add_u32 s8, s8, 278528
    s_waitcnt lgkmcnt(12)
    v_mfma_f32_32x32x16_bf16 v[16:31], a[168:171], v[148:151], v[16:31]
    ds_read_b64_tr_b16 v[136:137], v208 offset:12288
    v_mfma_f32_32x32x16_bf16 v[80:95], a[172:175], v[148:151], v[80:95]
    ds_read_b64_tr_b16 v[138:139], v208 offset:13312
    buffer_load_dwordx4 a[224:227], v246, s[12:15], s25 offen offset:0 sc1
    s_waitcnt lgkmcnt(12)
    v_mfma_f32_32x32x16_bf16 v[32:47], a[168:171], v[152:155], v[32:47]
    ds_read_b64_tr_b16 v[140:141], v208 offset:12544
    v_mfma_f32_32x32x16_bf16 v[96:111], a[172:175], v[152:155], v[96:111]
    ds_read_b64_tr_b16 v[142:143], v208 offset:13568
    buffer_load_dwordx4 a[228:231], v247, s[12:15], s25 offen offset:0 sc1
    s_waitcnt lgkmcnt(12)
    v_mfma_f32_32x32x16_bf16 v[48:63], a[168:171], v[156:159], v[48:63]
    ds_read_b64_tr_b16 v[144:145], v208 offset:12800
    v_mfma_f32_32x32x16_bf16 v[112:127], a[172:175], v[156:159], v[112:127]
    ds_read_b64_tr_b16 v[146:147], v208 offset:13824
    buffer_load_dwordx4 a[232:235], v246, s[12:15], s25 offen offset:1024 sc1
    s_waitcnt lgkmcnt(12)
    s_waitcnt vmcnt(20)
    v_mfma_f32_32x32x16_bf16 v[0:15], a[176:179], v[160:163], v[0:15]
    ds_read_b64_tr_b16 v[148:149], v208 offset:13056
    s_waitcnt vmcnt(25)
    ds_read2st64_b32 v[220:221], v241 offset0:64 offset1:68
    ds_read2st64_b32 v[222:223], v241 offset0:72 offset1:76
    s_waitcnt vmcnt(19)
    v_mfma_f32_32x32x16_bf16 v[64:79], a[180:183], v[160:163], v[64:79]
    ds_read_b64_tr_b16 v[150:151], v208 offset:14080
    buffer_load_dwordx4 a[236:239], v247, s[12:15], s25 offen offset:1024 sc1
    s_waitcnt lgkmcnt(14)
    v_mfma_f32_32x32x16_bf16 v[16:31], a[176:179], v[164:167], v[16:31]
    s_waitcnt lgkmcnt(1)
    v_max3_u32 v220, v220, v221, v222
    v_max_u32 v220, v220, v223
    v_cmp_eq_u32 vcc, -1, v220
    s_nop 4
    s_cbranch_vccnz p_vg1
p_wg1:
    s_barrier
    ds_read_b64_tr_b16 v[152:153], v208 offset:16384
    v_mfma_f32_32x32x16_bf16 v[80:95], a[180:183], v[164:167], v[80:95]
    ds_read_b64_tr_b16 v[154:155], v208 offset:17408
    s_mov_b32 m0, s9
    s_add_u32 s9, s9, 16384
    buffer_load_dwordx4 v204, s[12:15], s8 offen offset:0 sc1 lds
    v_mfma_f32_32x32x16_bf16 v[32:47], a[176:179], v[128:131], v[32:47]
    ds_read_b64_tr_b16 v[156:157], v208 offset:16640
    v_mfma_f32_32x32x16_bf16 v[96:111], a[180:183], v[128:131], v[96:111]
    ds_read_b64_tr_b16 v[158:159], v208 offset:17664
    buffer_load_dwordx4 v205, s[12:15], s8 offen offset:1024 sc1 lds
    v_mfma_f32_32x32x16_bf16 v[48:63], a[176:179], v[132:135], v[48:63]
    ds_read_b64_tr_b16 v[160:161], v208 offset:16896
    v_mfma_f32_32x32x16_bf16 v[112:127], a[180:183], v[132:135], v[112:127]
    ds_read_b64_tr_b16 v[162:163], v208 offset:17920
    buffer_load_dwordx4 v206, s[12:15], s8 offen offset:2048 sc1 lds
    s_waitcnt vmcnt(22)
    v_mfma_f32_32x32x16_bf16 v[0:15], a[184:187], v[136:139], v[0:15]
    ds_read_b64_tr_b16 v[164:165], v208 offset:17152
    s_waitcnt vmcnt(21)
    v_mfma_f32_32x32x16_bf16 v[64:79], a[188:191], v[136:139], v[64:79]
    ds_read_b64_tr_b16 v[166:167], v208 offset:18176
    buffer_load_dwordx4 v207, s[12:15], s8 offen offset:3072 sc1 lds
    s_add_u32 s8, s8, 278528
    v_mfma_f32_32x32x16_bf16 v[16:31], a[184:187], v[140:143], v[16:31]
    ds_read_b64_tr_b16 v[128:129], v208 offset:20480
    v_mfma_f32_32x32x16_bf16 v[80:95], a[188:191], v[140:143], v[80:95]
    ds_read_b64_tr_b16 v[130:131], v208 offset:21504
    buffer_load_dwordx4 a[240:243], v246, s[12:15], s25 offen offset:2048 sc1
    v_mfma_f32_32x32x16_bf16 v[32:47], a[184:187], v[144:147], v[32:47]
    ds_read_b64_tr_b16 v[132:133], v208 offset:20736
    v_mfma_f32_32x32x16_bf16 v[96:111], a[188:191], v[144:147], v[96:111]
    ds_read_b64_tr_b16 v[134:135], v208 offset:21760
    buffer_load_dwordx4 a[244:247], v247, s[12:15], s25 offen offset:2048 sc1
    s_waitcnt lgkmcnt(12)
    v_mfma_f32_32x32x16_bf16 v[48:63], a[184:187], v[148:151], v[48:63]
    ds_read_b64_tr_b16 v[136:137], v208 offset:20992
    v_mfma_f32_32x32x16_bf16 v[112:127], a[188:191], v[148:151], v[112:127]
    ds_read_b64_tr_b16 v[138:139], v208 offset:22016
    buffer_load_dwordx4 a[248:251], v246, s[12:15], s25 offen offset:3072 sc1
    s_waitcnt lgkmcnt(12)
    s_waitcnt vmcnt(24)
    v_mfma_f32_32x32x16_bf16 v[0:15], a[192:195], v[152:155], v[0:15]
    ds_read_b64_tr_b16 v[140:141], v208 offset:21248
    s_waitcnt vmcnt(23)
    v_mfma_f32_32x32x16_bf16 v[64:79], a[196:199], v[152:155], v[64:79]
    ds_read_b64_tr_b16 v[142:143], v208 offset:22272
    buffer_load_dwordx4 a[252:255], v247, s[12:15], s25 offen offset:3072 sc1
    s_waitcnt lgkmcnt(12)
    v_mfma_f32_32x32x16_bf16 v[16:31], a[192:195], v[156:159], v[16:31]
    ds_read_b64_tr_b16 v[144:145], v208 offset:24576
    v_mfma_f32_32x32x16_bf16 v[80:95], a[196:199], v[156:159], v[80:95]
    ds_read_b64_tr_b16 v[146:147], v208 offset:25600
    buffer_load_dwordx4 v[184:187], v246, s[12:15], s26 offen offset:0 sc1
    s_waitcnt lgkmcnt(12)
    v_mfma_f32_32x32x16_bf16 v[32:47], a[192:195], v[160:163], v[32:47]
    ds_read_b64_tr_b16 v[148:149], v208 offset:24832
    v_mfma_f32_32x32x16_bf16 v[96:111], a[196:199], v[160:163], v[96:111]
    ds_read_b64_tr_b16 v[150:151], v208 offset:25856
    buffer_load_dwordx4 v[188:191], v247, s[12:15], s26 offen offset:0 sc1
    s_waitcnt lgkmcnt(12)
    v_mfma_f32_32x32x16_bf16 v[48:63], a[192:195], v[164:167], v[48:63]
    ds_read_b64_tr_b16 v[152:153], v208 offset:25088
    v_mfma_f32_32x32x16_bf16 v[112:127], a[196:199], v[164:167], v[112:127]
    ds_read_b64_tr_b16 v[154:155], v208 offset:26112
    buffer_load_dwordx4 v[192:195], v246, s[12:15], s26 offen offset:1024 sc1
    s_waitcnt lgkmcnt(12)
    s_waitcnt vmcnt(26)
    v_mfma_f32_32x32x16_bf16 v[0:15], a[200:203], v[128:131], v[0:15]
    ds_read_b64_tr_b16 v[156:157], v208 offset:25344
    s_waitcnt vmcnt(25)
    v_mfma_f32_32x32x16_bf16 v[64:79], a[204:207], v[128:131], v[64:79]
    ds_read_b64_tr_b16 v[158:159], v208 offset:26368
    buffer_load_dwordx4 v[196:199], v247, s[12:15], s26 offen offset:1024 sc1
    s_waitcnt lgkmcnt(12)
    v_mfma_f32_32x32x16_bf16 v[16:31], a[200:203], v[132:135], v[16:31]
    ds_read_b64_tr_b16 v[160:161], v208 offset:28672
    v_mfma_f32_32x32x16_bf16 v[80:95], a[204:207], v[132:135], v[80:95]
    ds_read_b64_tr_b16 v[162:163], v208 offset:29696
    s_mov_b32 m0, s9
    s_add_u32 s9, s9, 16384
    buffer_load_dwordx4 v204, s[12:15], s8 offen offset:0 sc1 lds
    s_waitcnt lgkmcnt(12)
    v_mfma_f32_32x32x16_bf16 v[32:47], a[200:203], v[136:139], v[32:47]
    ds_read_b64_tr_b16 v[164:165], v208 offset:28928
    v_mfma_f32_32x32x16_bf16 v[96:111], a[204:207], v[136:139], v[96:111]
    ds_read_b64_tr_b16 v[166:167], v208 offset:29952
    buffer_load_dwordx4 v205, s[12:15], s8 offen offset:1024 sc1 lds
    s_waitcnt lgkmcnt(12)
    v_mfma_f32_32x32x16_bf16 v[48:63], a[200:203], v[140:143], v[48:63]
    ds_read_b64_tr_b16 v[128:129], v208 offset:29184
    s_waitcnt vmcnt(18)
    ds_read2st64_b32 v[220:221], v241 offset0:128 offset1:132
    ds_read2st64_b32 v[222:223], v241 offset0:136 offset1:140
    ds_read2st64_b32 v[214:215], v243 offset0:0 offset1:4
    v_mfma_f32_32x32x16_bf16 v[112:127], a[204:207], v[140:143], v[112:127]
    ds_read_b64_tr_b16 v[130:131], v208 offset:30208
    buffer_load_dwordx4 v206, s[12:15], s8 offen offset:2048 sc1 lds
    s_waitcnt lgkmcnt(15)
    v_mfma_f32_32x32x16_bf16 v[0:15], a[208:211], v[144:147], v[0:15]
    ds_read_b64_tr_b16 v[132:133], v208 offset:29440
    v_mfma_f32_32x32x16_bf16 v[64:79], a[212:215], v[144:147], v[64:79]
    ds_read_b64_tr_b16 v[134:135], v208 offset:30464
    buffer_load_dwordx4 v207, s[12:15], s8 offen offset:3072 sc1 lds
    s_add_u32 s8, s8, 278528
    s_waitcnt lgkmcnt(15)
    v_mfma_f32_32x32x16_bf16 v[16:31], a[208:211], v[148:151], v[16:31]
    s_waitcnt lgkmcnt(3)
    v_max3_u32 v220, v220, v221, v222
    v_max3_u32 v220, v220, v214, v215
    v_max_u32 v220, v220, v223
    v_cmp_eq_u32 vcc, -1, v220
    s_nop 4
    s_cbranch_vccnz p_vg2
p_wg2:
    s_barrier
    ds_read_b64_tr_b16 v[136:137], v208 offset:32768
    ds_read_b64_tr_b16 v[224:225], v210 offset:0
    ds_read_b64_tr_b16 v[226:227], v210 offset:1024
    ds_read_b64_tr_b16 v[228:229], v210 offset:4096
    v_mfma_f32_32x32x16_bf16 v[80:95], a[212:215], v[148:151], v[80:95]
    ds_read_b64_tr_b16 v[138:139], v208 offset:33792
    buffer_load_dwordx4 a[160:163], v246, s[12:15], s26 offen offset:2048 sc1
    ds_read_b64_tr_b16 v[230:231], v210 offset:5120
    v_mfma_f32_32x32x16_bf16 v[32:47], a[208:211], v[152:155], v[32:47]
    ds_read_b64_tr_b16 v[140:141], v208 offset:33024
    v_mfma_f32_32x32x16_bf16 v[96:111], a[212:215], v[152:155], v[96:111]
    ds_read_b64_tr_b16 v[142:143], v208 offset:34048
    buffer_load_dwordx4 a[164:167], v247, s[12:15], s26 offen offset:2048 sc1
    v_mfma_f32_32x32x16_bf16 v[48:63], a[208:211], v[156:159], v[48:63]
    ds_read_b64_tr_b16 v[144:145], v208 offset:33280
    v_mfma_f32_32x32x16_bf16 v[112:127], a[212:215], v[156:159], v[112:127]
    ds_read_b64_tr_b16 v[146:147], v208 offset:34304
    buffer_load_dwordx4 a[168:171], v246, s[12:15], s26 offen offset:3072 sc1
    s_waitcnt lgkmcnt(8)
    v_lshlrev_b32 v214, 16, v224
    v_and_b32 v215, 0xffff0000, v224
    v_mfma_f32_32x32x16_bf16 v[0:15], a[216:219], v[160:163], v[0:15]
    ds_read_b64_tr_b16 v[148:149], v208 offset:33536
    v_mul_f32 v212, v214, v214
    v_mul_f32 v213, v215, v215
    v_lshlrev_b32 v214, 16, v225
    v_and_b32 v215, 0xffff0000, v225
    v_fmac_f32 v212, v214, v214
    v_mfma_f32_32x32x16_bf16 v[64:79], a[220:223], v[160:163], v[64:79]
    ds_read_b64_tr_b16 v[150:151], v208 offset:34560
    buffer_load_dwordx4 a[172:175], v247, s[12:15], s26 offen offset:3072 sc1
    v_fmac_f32 v213, v215, v215
    s_waitcnt lgkmcnt(9)
    v_lshlrev_b32 v214, 16, v226
    v_mfma_f32_32x32x16_bf16 v[16:31], a[216:219], v[164:167], v[16:31]
    ds_read_b64_tr_b16 v[152:153], v208 offset:36864
    v_and_b32 v215, 0xffff0000, v226
    v_fmac_f32 v212, v214, v214
    v_fmac_f32 v213, v215, v215
    v_lshlrev_b32 v214, 16, v227
    v_and_b32 v215, 0xffff0000, v227
    v_mfma_f32_32x32x16_bf16 v[80:95], a[220:223], v[164:167], v[80:95]
    ds_read_b64_tr_b16 v[154:155], v208 offset:37888
    buffer_load_dwordx4 a[176:179], v246, s[12:15], s27 offen offset:0 sc1
    v_fmac_f32 v212, v214, v214
    v_fmac_f32 v213, v215, v215
    v_mfma_f32_32x32x16_bf16 v[32:47], a[216:219], v[128:131], v[32:47]
    ds_read_b64_tr_b16 v[156:157], v208 offset:37120
    s_waitcnt lgkmcnt(11)
    v_lshlrev_b32 v214, 16, v228
    v_and_b32 v215, 0xffff0000, v228
    v_fmac_f32 v212, v214, v214
    v_fmac_f32 v213, v215, v215
    v_lshlrev_b32 v214, 16, v229
    v_mfma_f32_32x32x16_bf16 v[96:111], a[220:223], v[128:131], v[96:111]
    ds_read_b64_tr_b16 v[158:159], v208 offset:38144
    buffer_load_dwordx4 a[180:183], v247, s[12:15], s27 offen offset:0 sc1
    v_and_b32 v215, 0xffff0000, v229
    v_fmac_f32 v212, v214, v214
    v_mfma_f32_32x32x16_bf16 v[48:63], a[216:219], v[132:135], v[48:63]
    ds_read_b64_tr_b16 v[160:161], v208 offset:37376
    s_waitcnt vmcnt(18)
    ds_read2st64_b32 v[220:221], v241 offset0:192 offset1:196
    ds_read2st64_b32 v[222:223], v241 offset0:200 offset1:204
    v_fmac_f32 v213, v215, v215
    s_waitcnt lgkmcnt(13)
    v_lshlrev_b32 v214, 16, v230
    v_mfma_f32_32x32x16_bf16 v[112:127], a[220:223], v[132:135], v[112:127]
    ds_read_b64_tr_b16 v[162:163], v208 offset:38400
    buffer_load_dwordx4 a[184:187], v246, s[12:15], s27 offen offset:1024 sc1
    v_and_b32 v215, 0xffff0000, v230
    v_fmac_f32 v212, v214, v214
    v_mfma_f32_32x32x16_bf16 v[0:15], a[224:227], v[136:139], v[0:15]
    ds_read_b64_tr_b16 v[164:165], v208 offset:37632
    v_fmac_f32 v213, v215, v215
    v_lshlrev_b32 v214, 16, v231
    v_and_b32 v215, 0xffff0000, v231
    v_fmac_f32 v212, v214, v214
    v_fmac_f32 v213, v215, v215
    v_mfma_f32_32x32x16_bf16 v[64:79], a[228:231], v[136:139], v[64:79]
    ds_read_b64_tr_b16 v[166:167], v208 offset:38656
    buffer_load_dwordx4 a[188:191], v247, s[12:15], s27 offen offset:1024 sc1
    v_add_f32 v212, v212, v213
    v_mov_b32 v213, v212
    s_waitcnt lgkmcnt(14)
    v_mfma_f32_32x32x16_bf16 v[16:31], a[224:227], v[140:143], v[16:31]
    ds_read_b64_tr_b16 v[128:129], v208 offset:40960
    v_permlane32_swap_b32 v212, v213
    v_add_f32 v212, v212, v213
    v_mfma_f32_32x32x16_bf16 v[80:95], a[228:231], v[140:143], v[80:95]
    ds_read_b64_tr_b16 v[130:131], v208 offset:41984
    s_mov_b32 m0, s9
    s_add_u32 s9, s9, 16384
    buffer_load_dwordx4 v204, s[12:15], s8 offen offset:0 sc1 lds
    s_waitcnt lgkmcnt(14)
    v_mfma_f32_32x32x16_bf16 v[32:47], a[224:227], v[144:147], v[32:47]
    ds_read_b64_tr_b16 v[132:133], v208 offset:41216
    s_waitcnt lgkmcnt(6)
    v_max3_u32 v220, v220, v221, v222
    v_max_u32 v220, v220, v223
    v_cmp_eq_u32 vcc, -1, v220
    s_nop 4
    s_cbranch_vccnz p_vg3
p_wg3:
    v_mfma_f32_32x32x16_bf16 v[96:111], a[228:231], v[144:147], v[96:111]
    ds_read_b64_tr_b16 v[134:135], v208 offset:42240
    buffer_load_dwordx4 v205, s[12:15], s8 offen offset:1024 sc1 lds
    buffer_store_dword v212, v232, s[12:15], s41 offen sc1
    v_mfma_f32_32x32x16_bf16 v[48:63], a[224:227], v[148:151], v[48:63]
    ds_read_b64_tr_b16 v[136:137], v208 offset:41472
    v_mfma_f32_32x32x16_bf16 v[112:127], a[228:231], v[148:151], v[112:127]
    ds_read_b64_tr_b16 v[138:139], v208 offset:42496
    v_mfma_f32_32x32x16_bf16 v[0:15], a[232:235], v[152:155], v[0:15]
    ds_read_b64_tr_b16 v[140:141], v208 offset:41728
    v_mfma_f32_32x32x16_bf16 v[64:79], a[236:239], v[152:155], v[64:79]
    ds_read_b64_tr_b16 v[142:143], v208 offset:42752
    buffer_load_dwordx4 v206, s[12:15], s8 offen offset:2048 sc1 lds
    v_mfma_f32_32x32x16_bf16 v[16:31], a[232:235], v[156:159], v[16:31]
    ds_read_b64_tr_b16 v[144:145], v208 offset:45056
    v_mfma_f32_32x32x16_bf16 v[80:95], a[236:239], v[156:159], v[80:95]
    ds_read_b64_tr_b16 v[146:147], v208 offset:46080
    buffer_load_dwordx4 v207, s[12:15], s8 offen offset:3072 sc1 lds
    s_add_u32 s8, s8, 278528
    s_waitcnt lgkmcnt(12)
    v_mfma_f32_32x32x16_bf16 v[32:47], a[232:235], v[160:163], v[32:47]
    ds_read_b64_tr_b16 v[148:149], v208 offset:45312
    v_mfma_f32_32x32x16_bf16 v[96:111], a[236:239], v[160:163], v[96:111]
    ds_read_b64_tr_b16 v[150:151], v208 offset:46336
    buffer_load_dwordx4 a[192:195], v246, s[12:15], s27 offen offset:2048 sc1
    s_waitcnt lgkmcnt(12)
    v_mfma_f32_32x32x16_bf16 v[48:63], a[232:235], v[164:167], v[48:63]
    ds_read_b64_tr_b16 v[152:153], v208 offset:45568
    v_mfma_f32_32x32x16_bf16 v[112:127], a[236:239], v[164:167], v[112:127]
    ds_read_b64_tr_b16 v[154:155], v208 offset:46592
    buffer_load_dwordx4 a[196:199], v247, s[12:15], s27 offen offset:2048 sc1
    s_waitcnt lgkmcnt(12)
    s_waitcnt vmcnt(26)
    v_mfma_f32_32x32x16_bf16 v[0:15], a[240:243], v[128:131], v[0:15]
    ds_read_b64_tr_b16 v[156:157], v208 offset:45824
    s_waitcnt vmcnt(25)
    v_mfma_f32_32x32x16_bf16 v[64:79], a[244:247], v[128:131], v[64:79]
    ds_read_b64_tr_b16 v[158:159], v208 offset:46848
    buffer_load_dwordx4 a[200:203], v246, s[12:15], s27 offen offset:3072 sc1
    s_waitcnt lgkmcnt(12)
    v_mfma_f32_32x32x16_bf16 v[16:31], a[240:243], v[132:135], v[16:31]
    s_barrier
    ds_read_b64_tr_b16 v[160:161], v208 offset:49152
    v_mfma_f32_32x32x16_bf16 v[80:95], a[244:247], v[132:135], v[80:95]
    ds_read_b64_tr_b16 v[162:163], v208 offset:50176
    buffer_load_dwordx4 a[204:207], v247, s[12:15], s27 offen offset:3072 sc1
    s_waitcnt lgkmcnt(12)
    v_mfma_f32_32x32x16_bf16 v[32:47], a[240:243], v[136:139], v[32:47]
    ds_read_b64_tr_b16 v[164:165], v208 offset:49408
    v_mfma_f32_32x32x16_bf16 v[96:111], a[244:247], v[136:139], v[96:111]
    ds_read_b64_tr_b16 v[166:167], v208 offset:50432
    s_mov_b32 m0, s9
    s_add_u32 s9, s9, 16384
    buffer_load_dwordx4 v204, s[12:15], s8 offen offset:0 sc1 lds
    s_waitcnt lgkmcnt(12)
    v_mfma_f32_32x32x16_bf16 v[48:63], a[240:243], v[140:143], v[48:63]
    ds_read_b64_tr_b16 v[128:129], v208 offset:49664
    s_waitcnt vmcnt(18)
    ds_read2st64_b32 v[220:221], v242 offset0:0 offset1:4
    ds_read2st64_b32 v[222:223], v242 offset0:8 offset1:12
    v_mfma_f32_32x32x16_bf16 v[112:127], a[244:247], v[140:143], v[112:127]
    ds_read_b64_tr_b16 v[130:131], v208 offset:50688
    buffer_load_dwordx4 v205, s[12:15], s8 offen offset:1024 sc1 lds
    s_waitcnt lgkmcnt(14)
    v_mfma_f32_32x32x16_bf16 v[0:15], a[248:251], v[144:147], v[0:15]
    ds_read_b64_tr_b16 v[132:133], v208 offset:49920
    v_mfma_f32_32x32x16_bf16 v[64:79], a[252:255], v[144:147], v[64:79]
    ds_read_b64_tr_b16 v[134:135], v208 offset:50944
    buffer_load_dwordx4 v206, s[12:15], s8 offen offset:2048 sc1 lds
    s_waitcnt lgkmcnt(14)
    v_mfma_f32_32x32x16_bf16 v[16:31], a[248:251], v[148:151], v[16:31]
    ds_read_b64_tr_b16 v[136:137], v208 offset:53248
    v_mfma_f32_32x32x16_bf16 v[80:95], a[252:255], v[148:151], v[80:95]
    ds_read_b64_tr_b16 v[138:139], v208 offset:54272
    buffer_load_dwordx4 v207, s[12:15], s8 offen offset:3072 sc1 lds
    s_add_u32 s8, s8, 278528
    s_waitcnt lgkmcnt(14)
    v_mfma_f32_32x32x16_bf16 v[32:47], a[248:251], v[152:155], v[32:47]
    ds_read_b64_tr_b16 v[140:141], v208 offset:53504
    s_waitcnt lgkmcnt(6)
    v_max3_u32 v220, v220, v221, v222
    v_max_u32 v220, v220, v223
    v_cmp_eq_u32 vcc, -1, v220
    s_nop 4
    s_cbranch_vccnz p_vg4
p_wg4:
    v_mfma_f32_32x32x16_bf16 v[96:111], a[252:255], v[152:155], v[96:111]
    ds_read_b64_tr_b16 v[142:143], v208 offset:54528
    buffer_load_dwordx4 a[208:211], v246, s[12:15], s32 offen offset:0 sc1
    v_mfma_f32_32x32x16_bf16 v[48:63], a[248:251], v[156:159], v[48:63]
    ds_read_b64_tr_b16 v[144:145], v208 offset:53760
    v_mfma_f32_32x32x16_bf16 v[112:127], a[252:255], v[156:159], v[112:127]
    ds_read_b64_tr_b16 v[146:147], v208 offset:54784
    buffer_load_dwordx4 a[212:215], v247, s[12:15], s32 offen offset:0 sc1
    v_mfma_f32_32x32x16_bf16 v[0:15], v[184:187], v[160:163], v[0:15]
    ds_read_b64_tr_b16 v[148:149], v208 offset:54016
    v_mfma_f32_32x32x16_bf16 v[64:79], v[188:191], v[160:163], v[64:79]
    ds_read_b64_tr_b16 v[150:151], v208 offset:55040
    s_mov_b32 m0, s9
    s_add_u32 s9, s9, 16384
    buffer_load_dwordx4 v204, s[12:15], s8 offen offset:0 sc1 lds
    v_mfma_f32_32x32x16_bf16 v[16:31], v[184:187], v[164:167], v[16:31]
    ds_read_b64_tr_b16 v[152:153], v208 offset:57344
    v_mfma_f32_32x32x16_bf16 v[80:95], v[188:191], v[164:167], v[80:95]
    ds_read_b64_tr_b16 v[154:155], v208 offset:58368
    buffer_load_dwordx4 v205, s[12:15], s8 offen offset:1024 sc1 lds
    s_waitcnt lgkmcnt(12)
    v_mfma_f32_32x32x16_bf16 v[32:47], v[184:187], v[128:131], v[32:47]
    ds_read_b64_tr_b16 v[156:157], v208 offset:57600
    v_mfma_f32_32x32x16_bf16 v[96:111], v[188:191], v[128:131], v[96:111]
    ds_read_b64_tr_b16 v[158:159], v208 offset:58624
    buffer_load_dwordx4 v206, s[12:15], s8 offen offset:2048 sc1 lds
    s_waitcnt lgkmcnt(12)
    v_mfma_f32_32x32x16_bf16 v[48:63], v[184:187], v[132:135], v[48:63]
    ds_read_b64_tr_b16 v[160:161], v208 offset:57856
    v_mfma_f32_32x32x16_bf16 v[112:127], v[188:191], v[132:135], v[112:127]
    ds_read_b64_tr_b16 v[162:163], v208 offset:58880
    buffer_load_dwordx4 v207, s[12:15], s8 offen offset:3072 sc1 lds
    s_add_u32 s8, s8, 278528
    s_waitcnt lgkmcnt(12)
    v_mfma_f32_32x32x16_bf16 v[0:15], v[192:195], v[136:139], v[0:15]
    ds_read_b64_tr_b16 v[164:165], v208 offset:58112
    v_mfma_f32_32x32x16_bf16 v[64:79], v[196:199], v[136:139], v[64:79]
    ds_read_b64_tr_b16 v[166:167], v208 offset:59136
    buffer_load_dwordx4 a[216:219], v246, s[12:15], s32 offen offset:1024 sc1
    s_waitcnt lgkmcnt(12)
    v_mfma_f32_32x32x16_bf16 v[16:31], v[192:195], v[140:143], v[16:31]
    ds_read_b64_tr_b16 v[128:129], v208 offset:61440
    v_mfma_f32_32x32x16_bf16 v[80:95], v[196:199], v[140:143], v[80:95]
    ds_read_b64_tr_b16 v[130:131], v208 offset:62464
    buffer_load_dwordx4 a[220:223], v247, s[12:15], s32 offen offset:1024 sc1
    s_waitcnt lgkmcnt(12)
    v_mfma_f32_32x32x16_bf16 v[32:47], v[192:195], v[144:147], v[32:47]
    ds_read_b64_tr_b16 v[132:133], v208 offset:61696
    v_mfma_f32_32x32x16_bf16 v[96:111], v[196:199], v[144:147], v[96:111]
    ds_read_b64_tr_b16 v[134:135], v208 offset:62720
    buffer_load_dwordx4 a[224:227], v246, s[12:15], s32 offen offset:2048 sc1
    s_waitcnt lgkmcnt(12)
    v_mfma_f32_32x32x16_bf16 v[48:63], v[192:195], v[148:151], v[48:63]
    ds_read_b64_tr_b16 v[136:137], v208 offset:61952
    v_mfma_f32_32x32x16_bf16 v[112:127], v[196:199], v[148:151], v[112:127]
    ds_read_b64_tr_b16 v[138:139], v208 offset:62976
    buffer_load_dwordx4 a[228:231], v247, s[12:15], s32 offen offset:2048 sc1
    s_waitcnt lgkmcnt(12)
    s_waitcnt vmcnt(30)
    v_mfma_f32_32x32x16_bf16 v[0:15], a[160:163], v[152:155], v[0:15]
    ds_read_b64_tr_b16 v[140:141], v208 offset:62208
    s_waitcnt vmcnt(18)
    ds_read2st64_b32 v[220:221], v242 offset0:64 offset1:68
    ds_read2st64_b32 v[222:223], v242 offset0:72 offset1:76
    v_mfma_f32_32x32x16_bf16 v[64:79], a[164:167], v[152:155], v[64:79]
    ds_read_b64_tr_b16 v[142:143], v208 offset:63232
    buffer_load_dwordx4 a[232:235], v246, s[12:15], s32 offen offset:3072 sc1
    s_waitcnt lgkmcnt(14)
    v_mfma_f32_32x32x16_bf16 v[16:31], a[160:163], v[156:159], v[16:31]
    s_barrier
    ds_read_b64_tr_b16 v[144:145], v209 offset:0
    v_mfma_f32_32x32x16_bf16 v[80:95], a[164:167], v[156:159], v[80:95]
    ds_read_b64_tr_b16 v[146:147], v209 offset:1024
    buffer_load_dwordx4 a[236:239], v247, s[12:15], s32 offen offset:3072 sc1
    s_waitcnt lgkmcnt(14)
    v_mfma_f32_32x32x16_bf16 v[32:47], a[160:163], v[160:163], v[32:47]
    ds_read_b64_tr_b16 v[148:149], v209 offset:256
    v_mfma_f32_32x32x16_bf16 v[96:111], a[164:167], v[160:163], v[96:111]
    ds_read_b64_tr_b16 v[150:151], v209 offset:1280
    buffer_load_dwordx4 a[240:243], v246, s[12:15], s33 offen offset:0 sc1
    s_waitcnt lgkmcnt(14)
    v_mfma_f32_32x32x16_bf16 v[48:63], a[160:163], v[164:167], v[48:63]
    ds_read_b64_tr_b16 v[152:153], v209 offset:512
    s_waitcnt lgkmcnt(6)
    v_max3_u32 v220, v220, v221, v222
    v_max_u32 v220, v220, v223
    v_cmp_eq_u32 vcc, -1, v220
    s_nop 4
    s_cbranch_vccnz p_vg5
p_wg5:
    v_mfma_f32_32x32x16_bf16 v[112:127], a[164:167], v[164:167], v[112:127]
    ds_read_b64_tr_b16 v[154:155], v209 offset:1536
    buffer_load_dwordx4 a[244:247], v247, s[12:15], s33 offen offset:0 sc1
    v_mfma_f32_32x32x16_bf16 v[0:15], a[168:171], v[128:131], v[0:15]
    ds_read_b64_tr_b16 v[156:157], v209 offset:768
    buffer_load_dwordx4 v[224:227], v235, s[12:15], s40 offen sc1
    buffer_load_dwordx4 v[228:231], v235, s[12:15], s56 offen sc1
    v_mfma_f32_32x32x16_bf16 v[64:79], a[172:175], v[128:131], v[64:79]
    ds_read_b64_tr_b16 v[158:159], v209 offset:1792
    v_mfma_f32_32x32x16_bf16 v[16:31], a[168:171], v[132:135], v[16:31]
    ds_read_b64_tr_b16 v[160:161], v209 offset:4096
    v_mfma_f32_32x32x16_bf16 v[80:95], a[172:175], v[132:135], v[80:95]
    ds_read_b64_tr_b16 v[162:163], v209 offset:5120
    buffer_load_dwordx4 a[248:251], v246, s[12:15], s33 offen offset:1024 sc1
    v_mfma_f32_32x32x16_bf16 v[32:47], a[168:171], v[136:139], v[32:47]
    ds_read_b64_tr_b16 v[164:165], v209 offset:4352
    v_mfma_f32_32x32x16_bf16 v[96:111], a[172:175], v[136:139], v[96:111]
    ds_read_b64_tr_b16 v[166:167], v209 offset:5376
    buffer_load_dwordx4 a[252:255], v247, s[12:15], s33 offen offset:1024 sc1
    s_waitcnt lgkmcnt(12)
    v_mfma_f32_32x32x16_bf16 v[48:63], a[168:171], v[140:143], v[48:63]
    ds_read_b64_tr_b16 v[128:129], v209 offset:4608
    v_mfma_f32_32x32x16_bf16 v[112:127], a[172:175], v[140:143], v[112:127]
    ds_read_b64_tr_b16 v[130:131], v209 offset:5632
    buffer_load_dwordx4 v[184:187], v246, s[12:15], s33 offen offset:2048 sc1
    s_waitcnt lgkmcnt(12)
    v_mfma_f32_32x32x16_bf16 v[0:15], a[176:179], v[144:147], v[0:15]
    ds_read_b64_tr_b16 v[132:133], v209 offset:4864
    s_waitcnt vmcnt(19)
    ds_read2st64_b32 v[220:221], v242 offset0:128 offset1:132
    ds_read2st64_b32 v[222:223], v242 offset0:136 offset1:140
    v_mfma_f32_32x32x16_bf16 v[64:79], a[180:183], v[144:147], v[64:79]
    ds_read_b64_tr_b16 v[134:135], v209 offset:5888
    buffer_load_dwordx4 v[188:191], v247, s[12:15], s33 offen offset:2048 sc1
    s_waitcnt lgkmcnt(14)
    v_mfma_f32_32x32x16_bf16 v[16:31], a[176:179], v[148:151], v[16:31]
    ds_read_b64_tr_b16 v[136:137], v209 offset:8192
    v_mfma_f32_32x32x16_bf16 v[80:95], a[180:183], v[148:151], v[80:95]
    ds_read_b64_tr_b16 v[138:139], v209 offset:9216
    buffer_load_dwordx4 v[192:195], v246, s[12:15], s33 offen offset:3072 sc1
    s_waitcnt lgkmcnt(14)
    v_mfma_f32_32x32x16_bf16 v[32:47], a[176:179], v[152:155], v[32:47]
    ds_read_b64_tr_b16 v[140:141], v209 offset:8448
    v_mfma_f32_32x32x16_bf16 v[96:111], a[180:183], v[152:155], v[96:111]
    ds_read_b64_tr_b16 v[142:143], v209 offset:9472
    buffer_load_dwordx4 v[196:199], v247, s[12:15], s33 offen offset:3072 sc1
    s_waitcnt lgkmcnt(14)
    v_mfma_f32_32x32x16_bf16 v[48:63], a[176:179], v[156:159], v[48:63]
    ds_read_b64_tr_b16 v[144:145], v209 offset:8704
    s_waitcnt lgkmcnt(6)
    v_max3_u32 v220, v220, v221, v222
    v_max_u32 v220, v220, v223
    v_cmp_eq_u32 vcc, -1, v220
    s_nop 4
    s_cbranch_vccnz p_vg6
p_wg6:
    v_mfma_f32_32x32x16_bf16 v[112:127], a[180:183], v[156:159], v[112:127]
    ds_read_b64_tr_b16 v[146:147], v209 offset:9728
    buffer_load_dwordx4 a[160:163], v246, s[12:15], s34 offen offset:0 sc1
    v_mfma_f32_32x32x16_bf16 v[0:15], a[184:187], v[160:163], v[0:15]
    ds_read_b64_tr_b16 v[148:149], v209 offset:8960
    v_mfma_f32_32x32x16_bf16 v[64:79], a[188:191], v[160:163], v[64:79]
    ds_read_b64_tr_b16 v[150:151], v209 offset:9984
    buffer_load_dwordx4 a[164:167], v247, s[12:15], s34 offen offset:0 sc1
    v_mfma_f32_32x32x16_bf16 v[16:31], a[184:187], v[164:167], v[16:31]
    ds_read_b64_tr_b16 v[152:153], v209 offset:12288
    v_mfma_f32_32x32x16_bf16 v[80:95], a[188:191], v[164:167], v[80:95]
    ds_read_b64_tr_b16 v[154:155], v209 offset:13312
    buffer_load_dwordx4 a[168:171], v246, s[12:15], s34 offen offset:1024 sc1
    v_mfma_f32_32x32x16_bf16 v[32:47], a[184:187], v[128:131], v[32:47]
    ds_read_b64_tr_b16 v[156:157], v209 offset:12544
    s_waitcnt vmcnt(19)
    ds_read2st64_b32 v[220:221], v242 offset0:192 offset1:196
    ds_read2st64_b32 v[222:223], v242 offset0:200 offset1:204
    v_mfma_f32_32x32x16_bf16 v[96:111], a[188:191], v[128:131], v[96:111]
    ds_read_b64_tr_b16 v[158:159], v209 offset:13568
    buffer_load_dwordx4 a[172:175], v247, s[12:15], s34 offen offset:1024 sc1
    s_waitcnt lgkmcnt(14)
    v_mfma_f32_32x32x16_bf16 v[48:63], a[184:187], v[132:135], v[48:63]
    ds_read_b64_tr_b16 v[160:161], v209 offset:12800
    v_mfma_f32_32x32x16_bf16 v[112:127], a[188:191], v[132:135], v[112:127]
    ds_read_b64_tr_b16 v[162:163], v209 offset:13824
    buffer_load_dwordx4 a[176:179], v246, s[12:15], s34 offen offset:2048 sc1
    s_waitcnt lgkmcnt(14)
    v_mfma_f32_32x32x16_bf16 v[0:15], a[192:195], v[136:139], v[0:15]
    ds_read_b64_tr_b16 v[164:165], v209 offset:13056
    v_mfma_f32_32x32x16_bf16 v[64:79], a[196:199], v[136:139], v[64:79]
    ds_read_b64_tr_b16 v[166:167], v209 offset:14080
    buffer_load_dwordx4 a[180:183], v247, s[12:15], s34 offen offset:2048 sc1
    s_waitcnt lgkmcnt(14)
    v_mfma_f32_32x32x16_bf16 v[16:31], a[192:195], v[140:143], v[16:31]
    s_barrier
    ds_read_b64_tr_b16 v[128:129], v209 offset:16384
    v_mfma_f32_32x32x16_bf16 v[80:95], a[196:199], v[140:143], v[80:95]
    ds_read_b64_tr_b16 v[130:131], v209 offset:17408
    buffer_load_dwordx4 a[184:187], v246, s[12:15], s34 offen offset:3072 sc1
    s_waitcnt lgkmcnt(14)
    v_mfma_f32_32x32x16_bf16 v[32:47], a[192:195], v[144:147], v[32:47]
    ds_read_b64_tr_b16 v[132:133], v209 offset:16640
    s_waitcnt lgkmcnt(8)
    v_max3_u32 v220, v220, v221, v222
    v_max_u32 v220, v220, v223
    v_cmp_eq_u32 vcc, -1, v220
    s_nop 4
    s_cbranch_vccnz p_vg7
p_wg7:
    v_mfma_f32_32x32x16_bf16 v[96:111], a[196:199], v[144:147], v[96:111]
    ds_read_b64_tr_b16 v[134:135], v209 offset:17664
    buffer_load_dwordx4 a[188:191], v247, s[12:15], s34 offen offset:3072 sc1
    v_mfma_f32_32x32x16_bf16 v[48:63], a[192:195], v[148:151], v[48:63]
    ds_read_b64_tr_b16 v[136:137], v209 offset:16896
    v_mfma_f32_32x32x16_bf16 v[112:127], a[196:199], v[148:151], v[112:127]
    ds_read_b64_tr_b16 v[138:139], v209 offset:17920
    v_mfma_f32_32x32x16_bf16 v[0:15], a[200:203], v[152:155], v[0:15]
    ds_read_b64_tr_b16 v[140:141], v209 offset:17152
    s_lshl_b32 s47, s54, 4
    s_add_u32 s47, s47, 32768
    s_add_u32 m0, s35, 0
    s_nop 0
    buffer_load_dwordx4 v250, s[28:31], s47 offen offset:0  lds
    v_mfma_f32_32x32x16_bf16 v[64:79], a[204:207], v[152:155], v[64:79]
    ds_read_b64_tr_b16 v[142:143], v209 offset:18176
    s_waitcnt lgkmcnt(12)
    v_mfma_f32_32x32x16_bf16 v[16:31], a[200:203], v[156:159], v[16:31]
    ds_read_b64_tr_b16 v[144:145], v209 offset:20480
    buffer_load_dwordx4 v251, s[28:31], s47 offen offset:1024  lds
    v_mfma_f32_32x32x16_bf16 v[80:95], a[204:207], v[156:159], v[80:95]
    ds_read_b64_tr_b16 v[146:147], v209 offset:21504
    s_waitcnt lgkmcnt(12)
    v_mfma_f32_32x32x16_bf16 v[32:47], a[200:203], v[160:163], v[32:47]
    ds_read_b64_tr_b16 v[148:149], v209 offset:20736
    s_waitcnt vmcnt(16)
    v_min3_f32 v214, v224, v225, v226
    v_min3_f32 v215, v227, v228, v229
    v_min3_f32 v214, v214, v230, v231
    v_min_f32 v214, v214, v215
    v_mfma_f32_32x32x16_bf16 v[96:111], a[204:207], v[160:163], v[96:111]
    ds_read_b64_tr_b16 v[150:151], v209 offset:21760
    buffer_load_dwordx4 v252, s[28:31], s47 offen offset:2048  lds
    s_waitcnt lgkmcnt(12)
    v_mfma_f32_32x32x16_bf16 v[48:63], a[200:203], v[164:167], v[48:63]
    ds_read_b64_tr_b16 v[152:153], v209 offset:20992
    v_cmp_gt_f32 vcc, 0, v214
    s_nop 4
    s_cbranch_vccnz p_sqretry
p_sqok:
    v_mfma_f32_32x32x16_bf16 v[112:127], a[204:207], v[164:167], v[112:127]
    ds_read_b64_tr_b16 v[154:155], v209 offset:22016
    v_add_f32 v224, v224, v228
    v_add_f32 v225, v225, v229
    v_add_f32 v226, v226, v230
    v_add_f32 v227, v227, v231
    s_waitcnt lgkmcnt(12)
    v_mfma_f32_32x32x16_bf16 v[0:15], a[208:211], v[128:131], v[0:15]
    ds_read_b64_tr_b16 v[156:157], v209 offset:21248
    v_mov_b32 v214, 0x3727c5ac
    v_add_u32 v232, 139264, v232
    v_permlane32_swap_b32 v224, v225
    v_permlane32_swap_b32 v226, v227
    v_add_f32 v224, v224, v225
    v_mfma_f32_32x32x16_bf16 v[64:79], a[212:215], v[128:131], v[64:79]
    ds_read_b64_tr_b16 v[158:159], v209 offset:22272
    v_add_f32 v226, v226, v227
    s_nop 1
    v_permlane16_swap_b32 v224, v226
    s_waitcnt lgkmcnt(12)
    v_mfma_f32_32x32x16_bf16 v[16:31], a[208:211], v[132:135], v[16:31]
    ds_read_b64_tr_b16 v[160:161], v209 offset:24576
    v_add_f32 v224, v224, v226
    s_nop 1
    v_add_f32_dpp v224, v224, v224 row_ror:8 row_mask:0xf bank_mask:0xf
    v_fmamk_f32 v224, v224, 0x3b000000, v214
    v_mfma_f32_32x32x16_bf16 v[80:95], a[212:215], v[132:135], v[80:95]
    ds_read_b64_tr_b16 v[162:163], v209 offset:25600
    ds_write_b32 v236, v224
    buffer_load_dwordx4 v253, s[28:31], s47 offen offset:3072  lds
    s_waitcnt lgkmcnt(13)
    v_mfma_f32_32x32x16_bf16 v[32:47], a[208:211], v[136:139], v[32:47]
    ds_read_b64_tr_b16 v[164:165], v209 offset:28672
    v_mfma_f32_32x32x16_bf16 v[96:111], a[212:215], v[136:139], v[96:111]
    ds_read_b64_tr_b16 v[166:167], v209 offset:29696
    s_waitcnt lgkmcnt(13)
    v_mfma_f32_32x32x16_bf16 v[48:63], a[208:211], v[140:143], v[48:63]
    ds_read_b64_tr_b16 v[128:129], v209 offset:32768
    s_waitcnt lgkmcnt(3)
    s_barrier
    ds_read_b32 v216, v232 offset:0
    ds_read_b32 v217, v232 offset:128
    ds_read_b32 v218, v232 offset:256
    v_mfma_f32_32x32x16_bf16 v[112:127], a[212:215], v[140:143], v[112:127]
    ds_read_b64_tr_b16 v[130:131], v209 offset:33792
    ds_read_b32 v219, v232 offset:384
    v_mfma_f32_32x32x16_bf16 v[0:15], a[216:219], v[144:147], v[0:15]
    ds_read_b64_tr_b16 v[132:133], v209 offset:36864
    s_lshl_b32 s47, s52, 4
    s_add_u32 m0, s99, 0
    s_nop 0
    buffer_load_dwordx4 v250, s[28:31], s47 offen offset:0  lds
    v_mfma_f32_32x32x16_bf16 v[64:79], a[220:223], v[144:147], v[64:79]
    ds_read_b64_tr_b16 v[134:135], v209 offset:37888
    v_mfma_f32_32x32x16_bf16 v[16:31], a[216:219], v[148:151], v[16:31]
    ds_read_b64_tr_b16 v[136:137], v209 offset:40960
    s_waitcnt lgkmcnt(7)
    v_rsq_f32 v220, v216
    s_waitcnt lgkmcnt(6)
    v_rsq_f32 v221, v217
    v_mfma_f32_32x32x16_bf16 v[80:95], a[220:223], v[148:151], v[80:95]
    ds_read_b64_tr_b16 v[138:139], v209 offset:41984
    s_waitcnt lgkmcnt(6)
    v_rsq_f32 v222, v218
    s_waitcnt lgkmcnt(4)
    v_rsq_f32 v223, v219
    v_mfma_f32_32x32x16_bf16 v[32:47], a[216:219], v[152:155], v[32:47]
    ds_read_b64_tr_b16 v[140:141], v209 offset:45056
    v_mul_f32 v216, v216, v220
    v_mul_f32 v220, 0xbfb8aa3b, v220
    v_mul_f32 v217, v217, v221
    v_mul_f32 v221, 0xbfb8aa3b, v221
    v_mul_f32 v218, v218, v222
    v_mfma_f32_32x32x16_bf16 v[96:111], a[220:223], v[152:155], v[96:111]
    ds_read_b64_tr_b16 v[142:143], v209 offset:46080
    v_mul_f32 v222, 0xbfb8aa3b, v222
    v_mul_f32 v219, v219, v223
    v_mul_f32 v223, 0xbfb8aa3b, v223
    v_mfma_f32_32x32x16_bf16 v[48:63], a[216:219], v[156:159], v[48:63]
    s_barrier
    ds_read_b64_tr_b16 v[144:145], v209 offset:49152
    buffer_load_dwordx4 v251, s[28:31], s47 offen offset:1024  lds
    v_mfma_f32_32x32x16_bf16 v[112:127], a[220:223], v[156:159], v[112:127]
    ds_read_b64_tr_b16 v[146:147], v209 offset:50176
    v_mfma_f32_32x32x16_bf16 v[0:15], a[224:227], v[160:163], v[0:15]
    ds_read_b64_tr_b16 v[148:149], v209 offset:53248
    buffer_load_dwordx4 v252, s[28:31], s47 offen offset:2048  lds
    v_mfma_f32_32x32x16_bf16 v[64:79], a[228:231], v[160:163], v[64:79]
    ds_read_b64_tr_b16 v[150:151], v209 offset:54272
    v_mfma_f32_32x32x16_bf16 v[0:15], a[232:235], v[164:167], v[0:15]
    ds_read_b64_tr_b16 v[152:153], v209 offset:57344
    buffer_load_dwordx4 v253, s[28:31], s47 offen offset:3072  lds
    v_mfma_f32_32x32x16_bf16 v[64:79], a[236:239], v[164:167], v[64:79]
    ds_read_b64_tr_b16 v[154:155], v209 offset:58368
    v_mfma_f32_32x32x16_bf16 v[0:15], a[240:243], v[128:131], v[0:15]
    ds_read_b64_tr_b16 v[156:157], v209 offset:61440
    s_lshl_b32 s47, s52, 4
    s_add_u32 s47, s47, 32768
    s_add_u32 m0, s99, 4096
    s_nop 0
    buffer_load_dwordx4 v250, s[28:31], s47 offen offset:0  lds
    v_mfma_f32_32x32x16_bf16 v[64:79], a[244:247], v[128:131], v[64:79]
    ds_read_b64_tr_b16 v[158:159], v209 offset:62464
    s_waitcnt lgkmcnt(12)
    s_waitcnt vmcnt(22)
    v_mfma_f32_32x32x16_bf16 v[0:15], a[248:251], v[132:135], v[0:15]
    ds_read_b64_tr_b16 v[160:161], v209 offset:24832
    buffer_load_dwordx4 v251, s[28:31], s47 offen offset:1024  lds
    s_waitcnt vmcnt(22)
    v_mfma_f32_32x32x16_bf16 v[64:79], a[252:255], v[132:135], v[64:79]
    ds_read_b64_tr_b16 v[162:163], v209 offset:25856
    s_waitcnt lgkmcnt(12)
    s_waitcnt vmcnt(21)
    v_mfma_f32_32x32x16_bf16 v[0:15], v[184:187], v[136:139], v[0:15]
    ds_read_b64_tr_b16 v[164:165], v209 offset:28928
    buffer_load_dwordx4 v252, s[28:31], s47 offen offset:2048  lds
    s_waitcnt vmcnt(21)
    v_mfma_f32_32x32x16_bf16 v[64:79], v[188:191], v[136:139], v[64:79]
    ds_read_b64_tr_b16 v[166:167], v209 offset:29952
    s_waitcnt lgkmcnt(12)
    s_waitcnt vmcnt(20)
    v_mfma_f32_32x32x16_bf16 v[0:15], v[192:195], v[140:143], v[0:15]
    ds_read_b64_tr_b16 v[128:129], v209 offset:33024
    buffer_load_dwordx4 v253, s[28:31], s47 offen offset:3072  lds
    s_waitcnt vmcnt(20)
    v_mfma_f32_32x32x16_bf16 v[64:79], v[196:199], v[140:143], v[64:79]
    ds_read_b64_tr_b16 v[130:131], v209 offset:34048
    s_waitcnt lgkmcnt(12)
    s_waitcnt vmcnt(19)
    v_mfma_f32_32x32x16_bf16 v[0:15], a[160:163], v[144:147], v[0:15]
    ds_read_b64_tr_b16 v[132:133], v209 offset:37120
    s_lshl_b32 s47, s53, 4
    s_add_u32 m0, s99, 8192
    s_nop 0
    buffer_load_dwordx4 v250, s[28:31], s47 offen offset:0  lds
    s_waitcnt vmcnt(19)
    v_mfma_f32_32x32x16_bf16 v[64:79], a[164:167], v[144:147], v[64:79]
    ds_read_b64_tr_b16 v[134:135], v209 offset:38144
    s_waitcnt lgkmcnt(12)
    s_waitcnt vmcnt(18)
    v_mfma_f32_32x32x16_bf16 v[0:15], a[168:171], v[148:151], v[0:15]
    ds_read_b64_tr_b16 v[136:137], v209 offset:41216
    buffer_load_dwordx4 v251, s[28:31], s47 offen offset:1024  lds
    s_waitcnt vmcnt(18)
    v_mfma_f32_32x32x16_bf16 v[64:79], a[172:175], v[148:151], v[64:79]
    ds_read_b64_tr_b16 v[138:139], v209 offset:42240
    s_waitcnt lgkmcnt(12)
    s_waitcnt vmcnt(17)
    v_mfma_f32_32x32x16_bf16 v[0:15], a[176:179], v[152:155], v[0:15]
    ds_read_b64_tr_b16 v[140:141], v209 offset:45312
    buffer_load_dwordx4 v252, s[28:31], s47 offen offset:2048  lds
    s_waitcnt vmcnt(17)
    v_mfma_f32_32x32x16_bf16 v[64:79], a[180:183], v[152:155], v[64:79]
    ds_read_b64_tr_b16 v[142:143], v209 offset:46336
    s_waitcnt lgkmcnt(12)
    s_waitcnt vmcnt(16)
    v_mfma_f32_32x32x16_bf16 v[0:15], a[184:187], v[156:159], v[0:15]
    ds_read_b64_tr_b16 v[144:145], v209 offset:49408
    buffer_load_dwordx4 v253, s[28:31], s47 offen offset:3072  lds
    s_waitcnt vmcnt(16)
    v_mfma_f32_32x32x16_bf16 v[64:79], a[188:191], v[156:159], v[64:79]
    ds_read_b64_tr_b16 v[146:147], v209 offset:50432
    s_waitcnt lgkmcnt(12)
    v_mfma_f32_32x32x16_bf16 v[16:31], a[224:227], v[160:163], v[16:31]
    ds_read_b64_tr_b16 v[148:149], v209 offset:53504
    s_lshl_b32 s47, s53, 4
    s_add_u32 s47, s47, 32768
    s_add_u32 m0, s99, 12288
    s_nop 0
    buffer_load_dwordx4 v250, s[28:31], s47 offen offset:0  lds
    v_mfma_f32_32x32x16_bf16 v[80:95], a[228:231], v[160:163], v[80:95]
    ds_read_b64_tr_b16 v[150:151], v209 offset:54528
    s_waitcnt lgkmcnt(12)
    v_mfma_f32_32x32x16_bf16 v[16:31], a[232:235], v[164:167], v[16:31]
    ds_read_b64_tr_b16 v[152:153], v209 offset:57600
    buffer_load_dwordx4 v251, s[28:31], s47 offen offset:1024  lds
    v_mul_f32 v0, v0, v220
    v_mul_f32 v1, v1, v220
    v_mul_f32 v2, v2, v220
    v_mul_f32 v3, v3, v220
    v_mfma_f32_32x32x16_bf16 v[80:95], a[236:239], v[164:167], v[80:95]
    ds_read_b64_tr_b16 v[154:155], v209 offset:58624
    v_exp_f32 v0, v0
    v_exp_f32 v1, v1
    v_exp_f32 v2, v2
    s_waitcnt lgkmcnt(12)
    v_mfma_f32_32x32x16_bf16 v[16:31], a[240:243], v[128:131], v[16:31]
    ds_read_b64_tr_b16 v[156:157], v209 offset:61696
    buffer_load_dwordx4 v252, s[28:31], s47 offen offset:2048  lds
    v_exp_f32 v3, v3
    v_fma_f32 v0, v0, v216, v216
    v_fma_f32 v1, v1, v216, v216
    v_fma_f32 v2, v2, v216, v216
    v_mfma_f32_32x32x16_bf16 v[80:95], a[244:247], v[128:131], v[80:95]
    ds_read_b64_tr_b16 v[158:159], v209 offset:62720
    v_fma_f32 v3, v3, v216, v216
    v_rcp_f32 v0, v0
    v_rcp_f32 v1, v1
    s_waitcnt lgkmcnt(12)
    v_mfma_f32_32x32x16_bf16 v[16:31], a[248:251], v[132:135], v[16:31]
    ds_read_b64_tr_b16 v[160:161], v209 offset:25088
    buffer_load_dwordx4 v253, s[28:31], s47 offen offset:3072  lds
    v_rcp_f32 v2, v2
    v_rcp_f32 v3, v3
    v_mul_f32 v8, v8, v0
    v_mfma_f32_32x32x16_bf16 v[80:95], a[252:255], v[132:135], v[80:95]
    ds_read_b64_tr_b16 v[162:163], v209 offset:26112
    v_mul_f32 v9, v9, v1
    v_mul_f32 v10, v10, v2
    v_mul_f32 v11, v11, v3
    v_cvt_pk_bf16_f32 v168, v8, v9
    v_cvt_pk_bf16_f32 v169, v10, v11
    v_mul_f32 v4, v4, v220
    s_waitcnt lgkmcnt(12)
    v_mfma_f32_32x32x16_bf16 v[16:31], v[184:187], v[136:139], v[16:31]
    ds_read_b64_tr_b16 v[164:165], v209 offset:29184
    s_lshl_b32 s47, s54, 4
    s_add_u32 m0, s99, 16384
    s_nop 0
    buffer_load_dwordx4 v250, s[28:31], s47 offen offset:0  lds
    v_mul_f32 v5, v5, v220
    v_mul_f32 v6, v6, v220
    v_mfma_f32_32x32x16_bf16 v[80:95], v[188:191], v[136:139], v[80:95]
    ds_read_b64_tr_b16 v[166:167], v209 offset:30208
    v_mul_f32 v7, v7, v220
    v_exp_f32 v4, v4
    v_exp_f32 v5, v5
    s_waitcnt lgkmcnt(12)
    v_mfma_f32_32x32x16_bf16 v[16:31], v[192:195], v[140:143], v[16:31]
    ds_read_b64_tr_b16 v[128:129], v209 offset:33280
    buffer_load_dwordx4 v251, s[28:31], s47 offen offset:1024  lds
    v_exp_f32 v6, v6
    v_exp_f32 v7, v7
    v_fma_f32 v4, v4, v216, v216
    v_mfma_f32_32x32x16_bf16 v[80:95], v[196:199], v[140:143], v[80:95]
    ds_read_b64_tr_b16 v[130:131], v209 offset:34304
    v_fma_f32 v5, v5, v216, v216
    v_fma_f32 v6, v6, v216, v216
    v_fma_f32 v7, v7, v216, v216
    v_rcp_f32 v4, v4
    s_waitcnt lgkmcnt(12)
    v_mfma_f32_32x32x16_bf16 v[16:31], a[160:163], v[144:147], v[16:31]
    ds_read_b64_tr_b16 v[132:133], v209 offset:37376
    buffer_load_dwordx4 v252, s[28:31], s47 offen offset:2048  lds
    v_rcp_f32 v5, v5
    v_rcp_f32 v6, v6
    v_mfma_f32_32x32x16_bf16 v[80:95], a[164:167], v[144:147], v[80:95]
    ds_read_b64_tr_b16 v[134:135], v209 offset:38400
    v_rcp_f32 v7, v7
    v_mul_f32 v12, v12, v4
    v_mul_f32 v13, v13, v5
    v_mul_f32 v14, v14, v6
    v_mul_f32 v15, v15, v7
    s_waitcnt lgkmcnt(12)
    v_mfma_f32_32x32x16_bf16 v[16:31], a[168:171], v[148:151], v[16:31]
    ds_read_b64_tr_b16 v[136:137], v209 offset:41472
    buffer_load_dwordx4 v253, s[28:31], s47 offen offset:3072  lds
    v_cvt_pk_bf16_f32 v170, v12, v13
    v_cvt_pk_bf16_f32 v171, v14, v15
    buffer_store_dwordx4 v[168:171], v201, s[12:15], s43 offen offset:0 sc1
    v_mul_f32 v64, v64, v220
    v_mfma_f32_32x32x16_bf16 v[80:95], a[172:175], v[148:151], v[80:95]
    ds_read_b64_tr_b16 v[138:139], v209 offset:42496
    v_mul_f32 v65, v65, v220
    v_mul_f32 v66, v66, v220
    v_mul_f32 v67, v67, v220
    v_exp_f32 v64, v64
    s_waitcnt lgkmcnt(12)
    v_mfma_f32_32x32x16_bf16 v[16:31], a[176:179], v[152:155], v[16:31]
    ds_read_b64_tr_b16 v[140:141], v209 offset:45568
    v_exp_f32 v65, v65
    v_exp_f32 v66, v66
    v_exp_f32 v67, v67
    v_fma_f32 v64, v64, v216, v216
    v_mfma_f32_32x32x16_bf16 v[80:95], a[180:183], v[152:155], v[80:95]
    ds_read_b64_tr_b16 v[142:143], v209 offset:46592
    v_fma_f32 v65, v65, v216, v216
    v_fma_f32 v66, v66, v216, v216
    v_fma_f32 v67, v67, v216, v216
    v_rcp_f32 v64, v64
    s_waitcnt lgkmcnt(12)
    v_mfma_f32_32x32x16_bf16 v[16:31], a[184:187], v[156:159], v[16:31]
    ds_read_b64_tr_b16 v[144:145], v209 offset:49664
    v_rcp_f32 v65, v65
    v_rcp_f32 v66, v66
    v_rcp_f32 v67, v67
    v_mul_f32 v72, v72, v64
    v_mfma_f32_32x32x16_bf16 v[80:95], a[188:191], v[156:159], v[80:95]
    ds_read_b64_tr_b16 v[146:147], v209 offset:50688
    v_mul_f32 v73, v73, v65
    v_mul_f32 v74, v74, v66
    v_mul_f32 v75, v75, v67
    v_cvt_pk_bf16_f32 v172, v72, v73
    v_cvt_pk_bf16_f32 v173, v74, v75
    v_mul_f32 v68, v68, v220
    s_waitcnt lgkmcnt(12)
    v_mfma_f32_32x32x16_bf16 v[32:47], a[224:227], v[160:163], v[32:47]
    ds_read_b64_tr_b16 v[148:149], v209 offset:53760
    v_mul_f32 v69, v69, v220
    v_mul_f32 v70, v70, v220
    v_mul_f32 v71, v71, v220
    v_exp_f32 v68, v68
    v_exp_f32 v69, v69
    v_mfma_f32_32x32x16_bf16 v[96:111], a[228:231], v[160:163], v[96:111]
    ds_read_b64_tr_b16 v[150:151], v209 offset:54784
    v_exp_f32 v70, v70
    v_exp_f32 v71, v71
    v_fma_f32 v68, v68, v216, v216
    v_fma_f32 v69, v69, v216, v216
    s_waitcnt lgkmcnt(12)
    v_mfma_f32_32x32x16_bf16 v[32:47], a[232:235], v[164:167], v[32:47]
    ds_read_b64_tr_b16 v[152:153], v209 offset:57856
    v_fma_f32 v70, v70, v216, v216
    v_fma_f32 v71, v71, v216, v216
    v_rcp_f32 v68, v68
    v_rcp_f32 v69, v69
    v_mfma_f32_32x32x16_bf16 v[96:111], a[236:239], v[164:167], v[96:111]
    ds_read_b64_tr_b16 v[154:155], v209 offset:58880
    v_rcp_f32 v70, v70
    v_rcp_f32 v71, v71
    v_mul_f32 v76, v76, v68
    v_mul_f32 v77, v77, v69
    s_waitcnt lgkmcnt(12)
    v_mfma_f32_32x32x16_bf16 v[32:47], a[240:243], v[128:131], v[32:47]
    ds_read_b64_tr_b16 v[156:157], v209 offset:61952
    v_mul_f32 v78, v78, v70
    v_mul_f32 v79, v79, v71
    v_cvt_pk_bf16_f32 v174, v76, v77
    v_cvt_pk_bf16_f32 v175, v78, v79
    buffer_store_dwordx4 v[172:175], v201, s[12:15], s43 offen offset:1024 sc1
    v_mul_f32 v16, v16, v221
    v_mfma_f32_32x32x16_bf16 v[96:111], a[244:247], v[128:131], v[96:111]
    ds_read_b64_tr_b16 v[158:159], v209 offset:62976
    v_mul_f32 v17, v17, v221
    v_mul_f32 v18, v18, v221
    v_mul_f32 v19, v19, v221
    v_exp_f32 v16, v16
    s_waitcnt lgkmcnt(12)
    v_mfma_f32_32x32x16_bf16 v[32:47], a[248:251], v[132:135], v[32:47]
    ds_read_b64_tr_b16 v[160:161], v209 offset:25344
    v_exp_f32 v17, v17
    v_exp_f32 v18, v18
    v_exp_f32 v19, v19
    v_fma_f32 v16, v16, v217, v217
    v_mfma_f32_32x32x16_bf16 v[96:111], a[252:255], v[132:135], v[96:111]
    ds_read_b64_tr_b16 v[162:163], v209 offset:26368
    v_fma_f32 v17, v17, v217, v217
    v_fma_f32 v18, v18, v217, v217
    v_fma_f32 v19, v19, v217, v217
    v_rcp_f32 v16, v16
    s_waitcnt lgkmcnt(12)
    v_mfma_f32_32x32x16_bf16 v[32:47], v[184:187], v[136:139], v[32:47]
    ds_read_b64_tr_b16 v[164:165], v209 offset:29440
    v_rcp_f32 v17, v17
    v_rcp_f32 v18, v18
    v_rcp_f32 v19, v19
    v_mul_f32 v24, v24, v16
    v_mfma_f32_32x32x16_bf16 v[96:111], v[188:191], v[136:139], v[96:111]
    ds_read_b64_tr_b16 v[166:167], v209 offset:30464
    v_mul_f32 v25, v25, v17
    v_mul_f32 v26, v26, v18
    v_mul_f32 v27, v27, v19
    v_cvt_pk_bf16_f32 v176, v24, v25
    v_cvt_pk_bf16_f32 v177, v26, v27
    v_mul_f32 v20, v20, v221
    s_waitcnt lgkmcnt(12)
    v_mfma_f32_32x32x16_bf16 v[32:47], v[192:195], v[140:143], v[32:47]
    ds_read_b64_tr_b16 v[128:129], v209 offset:33536
    v_mul_f32 v21, v21, v221
    v_mul_f32 v22, v22, v221
    v_mul_f32 v23, v23, v221
    v_exp_f32 v20, v20
    v_exp_f32 v21, v21
    v_mfma_f32_32x32x16_bf16 v[96:111], v[196:199], v[140:143], v[96:111]
    ds_read_b64_tr_b16 v[130:131], v209 offset:34560
    v_exp_f32 v22, v22
    v_exp_f32 v23, v23
    v_fma_f32 v20, v20, v217, v217
    v_fma_f32 v21, v21, v217, v217
    s_waitcnt lgkmcnt(12)
    v_mfma_f32_32x32x16_bf16 v[32:47], a[160:163], v[144:147], v[32:47]
    ds_read_b64_tr_b16 v[132:133], v209 offset:37632
    v_fma_f32 v22, v22, v217, v217
    v_fma_f32 v23, v23, v217, v217
    v_rcp_f32 v20, v20
    v_rcp_f32 v21, v21
    v_mfma_f32_32x32x16_bf16 v[96:111], a[164:167], v[144:147], v[96:111]
    ds_read_b64_tr_b16 v[134:135], v209 offset:38656
    v_rcp_f32 v22, v22
    v_rcp_f32 v23, v23
    v_mul_f32 v28, v28, v20
    v_mul_f32 v29, v29, v21
    s_waitcnt lgkmcnt(12)
    v_mfma_f32_32x32x16_bf16 v[32:47], a[168:171], v[148:151], v[32:47]
    ds_read_b64_tr_b16 v[136:137], v209 offset:41728
    v_mul_f32 v30, v30, v22
    v_mul_f32 v31, v31, v23
    v_cvt_pk_bf16_f32 v178, v28, v29
    v_cvt_pk_bf16_f32 v179, v30, v31
    buffer_store_dwordx4 v[176:179], v201, s[12:15], s44 offen offset:0 sc1
    v_mul_f32 v80, v80, v221
    v_mfma_f32_32x32x16_bf16 v[96:111], a[172:175], v[148:151], v[96:111]
    ds_read_b64_tr_b16 v[138:139], v209 offset:42752
    v_mul_f32 v81, v81, v221
    v_mul_f32 v82, v82, v221
    v_mul_f32 v83, v83, v221
    v_exp_f32 v80, v80
    s_waitcnt lgkmcnt(12)
    v_mfma_f32_32x32x16_bf16 v[32:47], a[176:179], v[152:155], v[32:47]
    ds_read_b64_tr_b16 v[140:141], v209 offset:45824
    v_exp_f32 v81, v81
    v_exp_f32 v82, v82
    v_exp_f32 v83, v83
    v_fma_f32 v80, v80, v217, v217
    v_mfma_f32_32x32x16_bf16 v[96:111], a[180:183], v[152:155], v[96:111]
    ds_read_b64_tr_b16 v[142:143], v209 offset:46848
    v_fma_f32 v81, v81, v217, v217
    v_fma_f32 v82, v82, v217, v217
    v_fma_f32 v83, v83, v217, v217
    v_rcp_f32 v80, v80
    s_waitcnt lgkmcnt(12)
    v_mfma_f32_32x32x16_bf16 v[32:47], a[184:187], v[156:159], v[32:47]
    ds_read_b64_tr_b16 v[144:145], v209 offset:49920
    v_rcp_f32 v81, v81
    v_rcp_f32 v82, v82
    v_rcp_f32 v83, v83
    v_mul_f32 v88, v88, v80
    v_mfma_f32_32x32x16_bf16 v[96:111], a[188:191], v[156:159], v[96:111]
    ds_read_b64_tr_b16 v[146:147], v209 offset:50944
    v_mul_f32 v89, v89, v81
    v_mul_f32 v90, v90, v82
    v_mul_f32 v91, v91, v83
    v_cvt_pk_bf16_f32 v180, v88, v89
    v_cvt_pk_bf16_f32 v181, v90, v91
    v_mul_f32 v84, v84, v221
    s_waitcnt lgkmcnt(12)
    v_mfma_f32_32x32x16_bf16 v[48:63], a[224:227], v[160:163], v[48:63]
    ds_read_b64_tr_b16 v[148:149], v209 offset:54016
    v_mul_f32 v85, v85, v221
    v_mul_f32 v86, v86, v221
    v_mul_f32 v87, v87, v221
    v_exp_f32 v84, v84
    v_exp_f32 v85, v85
    v_mfma_f32_32x32x16_bf16 v[112:127], a[228:231], v[160:163], v[112:127]
    ds_read_b64_tr_b16 v[150:151], v209 offset:55040
    v_exp_f32 v86, v86
    v_exp_f32 v87, v87
    v_fma_f32 v84, v84, v217, v217
    v_fma_f32 v85, v85, v217, v217
    s_waitcnt lgkmcnt(12)
    v_mfma_f32_32x32x16_bf16 v[48:63], a[232:235], v[164:167], v[48:63]
    ds_read_b64_tr_b16 v[152:153], v209 offset:58112
    v_fma_f32 v86, v86, v217, v217
    v_fma_f32 v87, v87, v217, v217
    v_rcp_f32 v84, v84
    v_rcp_f32 v85, v85
    v_mfma_f32_32x32x16_bf16 v[112:127], a[236:239], v[164:167], v[112:127]
    ds_read_b64_tr_b16 v[154:155], v209 offset:59136
    v_rcp_f32 v86, v86
    v_rcp_f32 v87, v87
    v_mul_f32 v92, v92, v84
    v_mul_f32 v93, v93, v85
    s_waitcnt lgkmcnt(12)
    v_mfma_f32_32x32x16_bf16 v[48:63], a[240:243], v[128:131], v[48:63]
    ds_read_b64_tr_b16 v[156:157], v209 offset:62208
    v_mul_f32 v94, v94, v86
    v_mul_f32 v95, v95, v87
    v_cvt_pk_bf16_f32 v182, v92, v93
    v_cvt_pk_bf16_f32 v183, v94, v95
    buffer_store_dwordx4 v[180:183], v201, s[12:15], s44 offen offset:1024 sc1
    v_mul_f32 v32, v32, v222
    v_mfma_f32_32x32x16_bf16 v[112:127], a[244:247], v[128:131], v[112:127]
    ds_read_b64_tr_b16 v[158:159], v209 offset:63232
    v_mul_f32 v33, v33, v222
    v_mul_f32 v34, v34, v222
    v_mul_f32 v35, v35, v222
    v_exp_f32 v32, v32
    s_waitcnt lgkmcnt(12)
    v_mfma_f32_32x32x16_bf16 v[48:63], a[248:251], v[132:135], v[48:63]
    v_exp_f32 v33, v33
    v_exp_f32 v34, v34
    v_exp_f32 v35, v35
    v_fma_f32 v32, v32, v218, v218
    v_fma_f32 v33, v33, v218, v218
    v_mfma_f32_32x32x16_bf16 v[112:127], a[252:255], v[132:135], v[112:127]
    v_fma_f32 v34, v34, v218, v218
    v_fma_f32 v35, v35, v218, v218
    v_rcp_f32 v32, v32
    v_rcp_f32 v33, v33
    s_waitcnt lgkmcnt(10)
    v_mfma_f32_32x32x16_bf16 v[48:63], v[184:187], v[136:139], v[48:63]
    v_rcp_f32 v34, v34
    v_rcp_f32 v35, v35
    v_mul_f32 v40, v40, v32
    v_mul_f32 v41, v41, v33
    v_mul_f32 v42, v42, v34
    v_mul_f32 v43, v43, v35
    v_mfma_f32_32x32x16_bf16 v[112:127], v[188:191], v[136:139], v[112:127]
    v_cvt_pk_bf16_f32 v168, v40, v41
    v_cvt_pk_bf16_f32 v169, v42, v43
    v_mul_f32 v36, v36, v222
    v_mul_f32 v37, v37, v222
    v_mul_f32 v38, v38, v222
    v_mul_f32 v39, v39, v222
    s_waitcnt lgkmcnt(8)
    v_mfma_f32_32x32x16_bf16 v[48:63], v[192:195], v[140:143], v[48:63]
    v_exp_f32 v36, v36
    v_exp_f32 v37, v37
    v_exp_f32 v38, v38
    v_exp_f32 v39, v39
    v_mfma_f32_32x32x16_bf16 v[112:127], v[196:199], v[140:143], v[112:127]
    v_fma_f32 v36, v36, v218, v218
    v_fma_f32 v37, v37, v218, v218
    v_fma_f32 v38, v38, v218, v218
    v_fma_f32 v39, v39, v218, v218
    v_rcp_f32 v36, v36
    s_waitcnt lgkmcnt(6)
    v_mfma_f32_32x32x16_bf16 v[48:63], a[160:163], v[144:147], v[48:63]
    v_rcp_f32 v37, v37
    v_rcp_f32 v38, v38
    v_rcp_f32 v39, v39
    v_mul_f32 v44, v44, v36
    v_mul_f32 v45, v45, v37
    v_mfma_f32_32x32x16_bf16 v[112:127], a[164:167], v[144:147], v[112:127]
    v_mul_f32 v46, v46, v38
    v_mul_f32 v47, v47, v39
    v_cvt_pk_bf16_f32 v170, v44, v45
    v_cvt_pk_bf16_f32 v171, v46, v47
    buffer_store_dwordx4 v[168:171], v201, s[12:15], s45 offen offset:0 sc1
    v_mul_f32 v96, v96, v222
    s_waitcnt lgkmcnt(4)
    v_mfma_f32_32x32x16_bf16 v[48:63], a[168:171], v[148:151], v[48:63]
    v_mul_f32 v97, v97, v222
    v_mul_f32 v98, v98, v222
    v_mul_f32 v99, v99, v222
    v_exp_f32 v96, v96
    v_exp_f32 v97, v97
    v_mfma_f32_32x32x16_bf16 v[112:127], a[172:175], v[148:151], v[112:127]
    v_exp_f32 v98, v98
    v_exp_f32 v99, v99
    v_fma_f32 v96, v96, v218, v218
    v_fma_f32 v97, v97, v218, v218
    v_fma_f32 v98, v98, v218, v218
    s_waitcnt lgkmcnt(2)
    v_mfma_f32_32x32x16_bf16 v[48:63], a[176:179], v[152:155], v[48:63]
    v_fma_f32 v99, v99, v218, v218
    v_rcp_f32 v96, v96
    v_rcp_f32 v97, v97
    v_rcp_f32 v98, v98
    v_mfma_f32_32x32x16_bf16 v[112:127], a[180:183], v[152:155], v[112:127]
    v_rcp_f32 v99, v99
    v_mul_f32 v104, v104, v96
    v_mul_f32 v105, v105, v97
    v_mul_f32 v106, v106, v98
    v_mul_f32 v107, v107, v99
    v_cvt_pk_bf16_f32 v172, v104, v105
    s_waitcnt lgkmcnt(0)
    v_mfma_f32_32x32x16_bf16 v[48:63], a[184:187], v[156:159], v[48:63]
    v_cvt_pk_bf16_f32 v173, v106, v107
    v_mul_f32 v100, v100, v222
    v_mul_f32 v101, v101, v222
    v_mul_f32 v102, v102, v222
    v_mul_f32 v103, v103, v222
    v_exp_f32 v100, v100
    v_mfma_f32_32x32x16_bf16 v[112:127], a[188:191], v[156:159], v[112:127]
    v_exp_f32 v101, v101
    v_exp_f32 v102, v102
    v_exp_f32 v103, v103
    v_fma_f32 v100, v100, v218, v218
    v_fma_f32 v101, v101, v218, v218
    v_fma_f32 v102, v102, v218, v218
    v_fma_f32 v103, v103, v218, v218
    v_rcp_f32 v100, v100
    v_rcp_f32 v101, v101
    v_rcp_f32 v102, v102
    v_rcp_f32 v103, v103
    v_mul_f32 v108, v108, v100
    v_mul_f32 v109, v109, v101
    v_mul_f32 v110, v110, v102
    v_mul_f32 v111, v111, v103
    v_cvt_pk_bf16_f32 v174, v108, v109
    v_cvt_pk_bf16_f32 v175, v110, v111
    buffer_store_dwordx4 v[172:175], v201, s[12:15], s45 offen offset:1024 sc1
    v_pk_mul_f32 v[48:49], v[48:49], v[222:223] op_sel:[0,1] op_sel_hi:[1,1]
    v_pk_mul_f32 v[50:51], v[50:51], v[222:223] op_sel:[0,1] op_sel_hi:[1,1]
    v_exp_f32 v48, v48
    v_exp_f32 v49, v49
    v_exp_f32 v50, v50
    v_exp_f32 v51, v51
    v_pk_fma_f32 v[48:49], v[48:49], v[218:219], v[218:219] op_sel:[0,1,1] op_sel_hi:[1,1,1]
    v_pk_fma_f32 v[50:51], v[50:51], v[218:219], v[218:219] op_sel:[0,1,1] op_sel_hi:[1,1,1]
    v_rcp_f32 v48, v48
    v_rcp_f32 v49, v49
    v_rcp_f32 v50, v50
    v_rcp_f32 v51, v51
    v_pk_mul_f32 v[56:57], v[56:57], v[48:49]
    v_pk_mul_f32 v[58:59], v[58:59], v[50:51]
    v_cvt_pk_bf16_f32 v176, v56, v57
    v_cvt_pk_bf16_f32 v177, v58, v59
    v_pk_mul_f32 v[52:53], v[52:53], v[222:223] op_sel:[0,1] op_sel_hi:[1,1]
    v_pk_mul_f32 v[54:55], v[54:55], v[222:223] op_sel:[0,1] op_sel_hi:[1,1]
    v_exp_f32 v52, v52
    v_exp_f32 v53, v53
    v_exp_f32 v54, v54
    v_exp_f32 v55, v55
    v_pk_fma_f32 v[52:53], v[52:53], v[218:219], v[218:219] op_sel:[0,1,1] op_sel_hi:[1,1,1]
    v_pk_fma_f32 v[54:55], v[54:55], v[218:219], v[218:219] op_sel:[0,1,1] op_sel_hi:[1,1,1]
    v_rcp_f32 v52, v52
    v_rcp_f32 v53, v53
    v_rcp_f32 v54, v54
    v_rcp_f32 v55, v55
    v_pk_mul_f32 v[60:61], v[60:61], v[52:53]
    v_pk_mul_f32 v[62:63], v[62:63], v[54:55]
    v_cvt_pk_bf16_f32 v178, v60, v61
    v_cvt_pk_bf16_f32 v179, v62, v63
    buffer_store_dwordx4 v[176:179], v201, s[12:15], s46 offen offset:0 sc1
    v_pk_mul_f32 v[112:113], v[112:113], v[222:223] op_sel:[0,1] op_sel_hi:[1,1]
    v_pk_mul_f32 v[114:115], v[114:115], v[222:223] op_sel:[0,1] op_sel_hi:[1,1]
    v_exp_f32 v112, v112
    v_exp_f32 v113, v113
    v_exp_f32 v114, v114
    v_exp_f32 v115, v115
    v_pk_fma_f32 v[112:113], v[112:113], v[218:219], v[218:219] op_sel:[0,1,1] op_sel_hi:[1,1,1]
    v_pk_fma_f32 v[114:115], v[114:115], v[218:219], v[218:219] op_sel:[0,1,1] op_sel_hi:[1,1,1]
    v_rcp_f32 v112, v112
    v_rcp_f32 v113, v113
    v_rcp_f32 v114, v114
    v_rcp_f32 v115, v115
    v_pk_mul_f32 v[120:121], v[120:121], v[112:113]
    v_pk_mul_f32 v[122:123], v[122:123], v[114:115]
    v_cvt_pk_bf16_f32 v180, v120, v121
    v_cvt_pk_bf16_f32 v181, v122, v123
    v_pk_mul_f32 v[116:117], v[116:117], v[222:223] op_sel:[0,1] op_sel_hi:[1,1]
    v_pk_mul_f32 v[118:119], v[118:119], v[222:223] op_sel:[0,1] op_sel_hi:[1,1]
    v_exp_f32 v116, v116
    v_exp_f32 v117, v117
    v_exp_f32 v118, v118
    v_exp_f32 v119, v119
    v_pk_fma_f32 v[116:117], v[116:117], v[218:219], v[218:219] op_sel:[0,1,1] op_sel_hi:[1,1,1]
    v_pk_fma_f32 v[118:119], v[118:119], v[218:219], v[218:219] op_sel:[0,1,1] op_sel_hi:[1,1,1]
    v_rcp_f32 v116, v116
    v_rcp_f32 v117, v117
    v_rcp_f32 v118, v118
    v_rcp_f32 v119, v119
    v_pk_mul_f32 v[124:125], v[124:125], v[116:117]
    v_pk_mul_f32 v[126:127], v[126:127], v[118:119]
    v_cvt_pk_bf16_f32 v182, v124, v125
    v_cvt_pk_bf16_f32 v183, v126, v127
    buffer_store_dwordx4 v[180:183], v201, s[12:15], s46 offen offset:1024 sc1
    s_waitcnt vmcnt(3)
    s_branch p_sync3
p_sqretry:
    s_mov_b32 s58, 0
p_sqloop:
    buffer_load_dwordx4 v[224:227], v235, s[12:15], s40 offen sc1
    buffer_load_dwordx4 v[228:231], v235, s[12:15], s56 offen sc1
    s_add_u32 s58, s58, 1
    s_waitcnt vmcnt(0)
    s_cmp_ge_u32 s58, 32768
    s_cbranch_scc1 p_sqok
    v_min3_f32 v214, v224, v225, v226
    v_min3_f32 v215, v227, v228, v229
    v_min3_f32 v214, v214, v230, v231
    v_min_f32 v214, v214, v215
    v_cmp_gt_f32 vcc, 0, v214
    s_nop 4
    s_cbranch_vccnz p_sqloop
    s_branch p_sqok
p_hpath:
    v_bfe_u32 v202, v200, 3, 2
    v_lshlrev_b32 v202, 6, v202
    v_and_b32 v203, 7, v200
    v_lshl_add_u32 v202, v203, 2, v202
    s_lshl_b32 s43, s4, 10
    s_add_u32 s43, s43, 0x410000
    buffer_load_dword v216, v202, s[12:15], s43 offen offset:0 sc1
    buffer_load_dword v217, v202, s[12:15], s43 offen offset:256 sc1
    buffer_load_dword v218, v202, s[12:15], s43 offen offset:512 sc1
    buffer_load_dword v219, v202, s[12:15], s43 offen offset:768 sc1
    s_sub_u32 s43, s5, 14
    s_lshl_b32 s43, s43, 2
    s_add_u32 s43, s43, s3
    s_lshl_b32 s43, s43, 12
    s_lshl_b32 s44, s4, 17
    s_add_u32 s43, s43, s44
    s_add_u32 s43, s43, 0x6c0000
    s_add_u32 s44, s43, 32768
    s_add_u32 s45, s43, 65536
    s_add_u32 s46, s43, 98304
    s_waitcnt vmcnt(24)
    ds_read2st64_b32 v[220:221], v241 offset0:0 offset1:4
    ds_read2st64_b32 v[222:223], v241 offset0:8 offset1:12
    s_waitcnt lgkmcnt(0)
    v_max3_u32 v220, v220, v221, v222
    v_max_u32 v220, v220, v223
    v_cmp_eq_u32 vcc, -1, v220
    s_nop 4
    s_cbranch_vccnz p_vh0
p_wh0:
    s_barrier
    ds_read_b64_tr_b16 v[128:129], v208 offset:0
    ds_read_b64_tr_b16 v[130:131], v208 offset:1024
    ds_read_b64_tr_b16 v[132:133], v208 offset:256
    ds_read_b64_tr_b16 v[134:135], v208 offset:1280
    ds_read_b64_tr_b16 v[136:137], v208 offset:512
    ds_read_b64_tr_b16 v[138:139], v208 offset:1536
    ds_read_b64_tr_b16 v[140:141], v208 offset:768
    ds_read_b64_tr_b16 v[142:143], v208 offset:1792
    ds_read_b64_tr_b16 v[144:145], v208 offset:4096
    ds_read_b64_tr_b16 v[146:147], v208 offset:5120
    ds_read_b64_tr_b16 v[148:149], v208 offset:4352
    ds_read_b64_tr_b16 v[150:151], v208 offset:5376
    ds_read_b64_tr_b16 v[152:153], v208 offset:4608
    ds_read_b64_tr_b16 v[154:155], v208 offset:5632
    s_mov_b32 m0, s11
    s_nop 0
    buffer_load_dwordx4 v204, s[12:15], s10 offen offset:0 sc1 lds
    buffer_load_dwordx4 v205, s[12:15], s10 offen offset:1024 sc1 lds
    s_waitcnt lgkmcnt(12)
    s_waitcnt vmcnt(21)
    v_mfma_f32_32x32x16_bf16 v[0:15], a[160:163], v[128:131], 0
    ds_read_b64_tr_b16 v[156:157], v208 offset:4864
    s_waitcnt vmcnt(20)
    v_mfma_f32_32x32x16_bf16 v[64:79], a[164:167], v[128:131], 0
    ds_read_b64_tr_b16 v[158:159], v208 offset:5888
    s_waitcnt lgkmcnt(12)
    v_mfma_f32_32x32x16_bf16 v[16:31], a[160:163], v[132:135], 0
    ds_read_b64_tr_b16 v[160:161], v208 offset:8192
    v_mfma_f32_32x32x16_bf16 v[80:95], a[164:167], v[132:135], 0
    ds_read_b64_tr_b16 v[162:163], v208 offset:9216
    s_mov_b32 m0, s9
    s_add_u32 s9, s9, 16384
    buffer_load_dwordx4 v204, s[12:15], s8 offen offset:0 sc1 lds
    s_waitcnt lgkmcnt(12)
    v_mfma_f32_32x32x16_bf16 v[32:47], a[160:163], v[136:139], 0
    ds_read_b64_tr_b16 v[164:165], v208 offset:8448
    v_mfma_f32_32x32x16_bf16 v[96:111], a[164:167], v[136:139], 0
    ds_read_b64_tr_b16 v[166:167], v208 offset:9472
    buffer_load_dwordx4 v205, s[12:15], s8 offen offset:1024 sc1 lds
    s_waitcnt lgkmcnt(12)
    v_mfma_f32_32x32x16_bf16 v[48:63], a[160:163], v[140:143], 0
    ds_read_b64_tr_b16 v[128:129], v208 offset:8704
    v_mfma_f32_32x32x16_bf16 v[112:127], a[164:167], v[140:143], 0
    ds_read_b64_tr_b16 v[130:131], v208 offset:9728
    buffer_load_dwordx4 v206, s[12:15], s8 offen offset:2048 sc1 lds
    s_waitcnt lgkmcnt(12)
    s_waitcnt vmcnt(22)
    v_mfma_f32_32x32x16_bf16 v[0:15], a[168:171], v[144:147], v[0:15]
    ds_read_b64_tr_b16 v[132:133], v208 offset:8960
    s_waitcnt vmcnt(21)
    v_mfma_f32_32x32x16_bf16 v[64:79], a[172:175], v[144:147], v[64:79]
    ds_read_b64_tr_b16 v[134:135], v208 offset:9984
    buffer_load_dwordx4 v207, s[12:15], s8 offen offset:3072 sc1 lds
    s_add_u32 s8, s8, 278528
    s_waitcnt lgkmcnt(12)
    v_mfma_f32_32x32x16_bf16 v[16:31], a[168:171], v[148:151], v[16:31]
    ds_read_b64_tr_b16 v[136:137], v208 offset:12288
    v_mfma_f32_32x32x16_bf16 v[80:95], a[172:175], v[148:151], v[80:95]
    ds_read_b64_tr_b16 v[138:139], v208 offset:13312
    buffer_load_dwordx4 a[224:227], v246, s[12:15], s25 offen offset:0 sc1
    s_waitcnt lgkmcnt(12)
    v_mfma_f32_32x32x16_bf16 v[32:47], a[168:171], v[152:155], v[32:47]
    ds_read_b64_tr_b16 v[140:141], v208 offset:12544
    v_mfma_f32_32x32x16_bf16 v[96:111], a[172:175], v[152:155], v[96:111]
    ds_read_b64_tr_b16 v[142:143], v208 offset:13568
    buffer_load_dwordx4 a[228:231], v247, s[12:15], s25 offen offset:0 sc1
    s_waitcnt lgkmcnt(12)
    v_mfma_f32_32x32x16_bf16 v[48:63], a[168:171], v[156:159], v[48:63]
    ds_read_b64_tr_b16 v[144:145], v208 offset:12800
    v_mfma_f32_32x32x16_bf16 v[112:127], a[172:175], v[156:159], v[112:127]
    ds_read_b64_tr_b16 v[146:147], v208 offset:13824
    buffer_load_dwordx4 a[232:235], v246, s[12:15], s25 offen offset:1024 sc1
    s_waitcnt lgkmcnt(12)
    s_waitcnt vmcnt(24)
    v_mfma_f32_32x32x16_bf16 v[0:15], a[176:179], v[160:163], v[0:15]
    ds_read_b64_tr_b16 v[148:149], v208 offset:13056
    s_waitcnt vmcnt(29)
    ds_read2st64_b32 v[220:221], v241 offset0:64 offset1:68
    ds_read2st64_b32 v[222:223], v241 offset0:72 offset1:76
    s_waitcnt vmcnt(23)
    v_mfma_f32_32x32x16_bf16 v[64:79], a[180:183], v[160:163], v[64:79]
    ds_read_b64_tr_b16 v[150:151], v208 offset:14080
    buffer_load_dwordx4 a[236:239], v247, s[12:15], s25 offen offset:1024 sc1
    s_waitcnt lgkmcnt(14)
    v_mfma_f32_32x32x16_bf16 v[16:31], a[176:179], v[164:167], v[16:31]
    s_waitcnt lgkmcnt(1)
    v_max3_u32 v220, v220, v221, v222
    v_max_u32 v220, v220, v223
    v_cmp_eq_u32 vcc, -1, v220
    s_nop 4
    s_cbranch_vccnz p_vh1
p_wh1:
    s_barrier
    ds_read_b64_tr_b16 v[152:153], v208 offset:16384
    v_mfma_f32_32x32x16_bf16 v[80:95], a[180:183], v[164:167], v[80:95]
    ds_read_b64_tr_b16 v[154:155], v208 offset:17408
    s_mov_b32 m0, s9
    s_add_u32 s9, s9, 16384
    buffer_load_dwordx4 v204, s[12:15], s8 offen offset:0 sc1 lds
    v_mfma_f32_32x32x16_bf16 v[32:47], a[176:179], v[128:131], v[32:47]
    ds_read_b64_tr_b16 v[156:157], v208 offset:16640
    v_mfma_f32_32x32x16_bf16 v[96:111], a[180:183], v[128:131], v[96:111]
    ds_read_b64_tr_b16 v[158:159], v208 offset:17664
    buffer_load_dwordx4 v205, s[12:15], s8 offen offset:1024 sc1 lds
    v_mfma_f32_32x32x16_bf16 v[48:63], a[176:179], v[132:135], v[48:63]
    ds_read_b64_tr_b16 v[160:161], v208 offset:16896
    v_mfma_f32_32x32x16_bf16 v[112:127], a[180:183], v[132:135], v[112:127]
    ds_read_b64_tr_b16 v[162:163], v208 offset:17920
    buffer_load_dwordx4 v206, s[12:15], s8 offen offset:2048 sc1 lds
    s_waitcnt vmcnt(26)
    v_mfma_f32_32x32x16_bf16 v[0:15], a[184:187], v[136:139], v[0:15]
    ds_read_b64_tr_b16 v[164:165], v208 offset:17152
    s_waitcnt vmcnt(25)
    v_mfma_f32_32x32x16_bf16 v[64:79], a[188:191], v[136:139], v[64:79]
    ds_read_b64_tr_b16 v[166:167], v208 offset:18176
    buffer_load_dwordx4 v207, s[12:15], s8 offen offset:3072 sc1 lds
    s_add_u32 s8, s8, 278528
    v_mfma_f32_32x32x16_bf16 v[16:31], a[184:187], v[140:143], v[16:31]
    ds_read_b64_tr_b16 v[128:129], v208 offset:20480
    v_mfma_f32_32x32x16_bf16 v[80:95], a[188:191], v[140:143], v[80:95]
    ds_read_b64_tr_b16 v[130:131], v208 offset:21504
    buffer_load_dwordx4 a[240:243], v246, s[12:15], s25 offen offset:2048 sc1
    v_mfma_f32_32x32x16_bf16 v[32:47], a[184:187], v[144:147], v[32:47]
    ds_read_b64_tr_b16 v[132:133], v208 offset:20736
    v_mfma_f32_32x32x16_bf16 v[96:111], a[188:191], v[144:147], v[96:111]
    ds_read_b64_tr_b16 v[134:135], v208 offset:21760
    buffer_load_dwordx4 a[244:247], v247, s[12:15], s25 offen offset:2048 sc1
    s_waitcnt lgkmcnt(12)
    v_mfma_f32_32x32x16_bf16 v[48:63], a[184:187], v[148:151], v[48:63]
    ds_read_b64_tr_b16 v[136:137], v208 offset:20992
    v_mfma_f32_32x32x16_bf16 v[112:127], a[188:191], v[148:151], v[112:127]
    ds_read_b64_tr_b16 v[138:139], v208 offset:22016
    buffer_load_dwordx4 a[248:251], v246, s[12:15], s25 offen offset:3072 sc1
    s_waitcnt lgkmcnt(12)
    s_waitcnt vmcnt(28)
    v_mfma_f32_32x32x16_bf16 v[0:15], a[192:195], v[152:155], v[0:15]
    ds_read_b64_tr_b16 v[140:141], v208 offset:21248
    s_waitcnt vmcnt(27)
    v_mfma_f32_32x32x16_bf16 v[64:79], a[196:199], v[152:155], v[64:79]
    ds_read_b64_tr_b16 v[142:143], v208 offset:22272
    buffer_load_dwordx4 a[252:255], v247, s[12:15], s25 offen offset:3072 sc1
    s_waitcnt lgkmcnt(12)
    v_mfma_f32_32x32x16_bf16 v[16:31], a[192:195], v[156:159], v[16:31]
    ds_read_b64_tr_b16 v[144:145], v208 offset:24576
    v_mfma_f32_32x32x16_bf16 v[80:95], a[196:199], v[156:159], v[80:95]
    ds_read_b64_tr_b16 v[146:147], v208 offset:25600
    buffer_load_dwordx4 v[184:187], v246, s[12:15], s26 offen offset:0 sc1
    s_waitcnt lgkmcnt(12)
    v_mfma_f32_32x32x16_bf16 v[32:47], a[192:195], v[160:163], v[32:47]
    ds_read_b64_tr_b16 v[148:149], v208 offset:24832
    v_mfma_f32_32x32x16_bf16 v[96:111], a[196:199], v[160:163], v[96:111]
    ds_read_b64_tr_b16 v[150:151], v208 offset:25856
    buffer_load_dwordx4 v[188:191], v247, s[12:15], s26 offen offset:0 sc1
    s_waitcnt lgkmcnt(12)
    v_mfma_f32_32x32x16_bf16 v[48:63], a[192:195], v[164:167], v[48:63]
    ds_read_b64_tr_b16 v[152:153], v208 offset:25088
    v_mfma_f32_32x32x16_bf16 v[112:127], a[196:199], v[164:167], v[112:127]
    ds_read_b64_tr_b16 v[154:155], v208 offset:26112
    buffer_load_dwordx4 v[192:195], v246, s[12:15], s26 offen offset:1024 sc1
    s_waitcnt lgkmcnt(12)
    s_waitcnt vmcnt(30)
    v_mfma_f32_32x32x16_bf16 v[0:15], a[200:203], v[128:131], v[0:15]
    ds_read_b64_tr_b16 v[156:157], v208 offset:25344
    s_waitcnt vmcnt(29)
    v_mfma_f32_32x32x16_bf16 v[64:79], a[204:207], v[128:131], v[64:79]
    ds_read_b64_tr_b16 v[158:159], v208 offset:26368
    buffer_load_dwordx4 v[196:199], v247, s[12:15], s26 offen offset:1024 sc1
    s_waitcnt lgkmcnt(12)
    v_mfma_f32_32x32x16_bf16 v[16:31], a[200:203], v[132:135], v[16:31]
    ds_read_b64_tr_b16 v[160:161], v208 offset:28672
    v_mfma_f32_32x32x16_bf16 v[80:95], a[204:207], v[132:135], v[80:95]
    ds_read_b64_tr_b16 v[162:163], v208 offset:29696
    s_mov_b32 m0, s9
    s_add_u32 s9, s9, 16384
    buffer_load_dwordx4 v204, s[12:15], s8 offen offset:0 sc1 lds
    s_waitcnt lgkmcnt(12)
    v_mfma_f32_32x32x16_bf16 v[32:47], a[200:203], v[136:139], v[32:47]
    ds_read_b64_tr_b16 v[164:165], v208 offset:28928
    v_mfma_f32_32x32x16_bf16 v[96:111], a[204:207], v[136:139], v[96:111]
    ds_read_b64_tr_b16 v[166:167], v208 offset:29952
    buffer_load_dwordx4 v205, s[12:15], s8 offen offset:1024 sc1 lds
    s_waitcnt lgkmcnt(12)
    v_mfma_f32_32x32x16_bf16 v[48:63], a[200:203], v[140:143], v[48:63]
    ds_read_b64_tr_b16 v[128:129], v208 offset:29184
    s_waitcnt vmcnt(18)
    ds_read2st64_b32 v[220:221], v241 offset0:128 offset1:132
    ds_read2st64_b32 v[222:223], v241 offset0:136 offset1:140
    ds_read2st64_b32 v[214:215], v243 offset0:0 offset1:4
    v_mfma_f32_32x32x16_bf16 v[112:127], a[204:207], v[140:143], v[112:127]
    ds_read_b64_tr_b16 v[130:131], v208 offset:30208
    buffer_load_dwordx4 v206, s[12:15], s8 offen offset:2048 sc1 lds
    s_waitcnt lgkmcnt(15)
    v_mfma_f32_32x32x16_bf16 v[0:15], a[208:211], v[144:147], v[0:15]
    ds_read_b64_tr_b16 v[132:133], v208 offset:29440
    v_mfma_f32_32x32x16_bf16 v[64:79], a[212:215], v[144:147], v[64:79]
    ds_read_b64_tr_b16 v[134:135], v208 offset:30464
    buffer_load_dwordx4 v207, s[12:15], s8 offen offset:3072 sc1 lds
    s_add_u32 s8, s8, 278528
    s_waitcnt lgkmcnt(15)
    v_mfma_f32_32x32x16_bf16 v[16:31], a[208:211], v[148:151], v[16:31]
    s_waitcnt lgkmcnt(3)
    v_max3_u32 v220, v220, v221, v222
    v_max3_u32 v220, v220, v214, v215
    v_max_u32 v220, v220, v223
    v_cmp_eq_u32 vcc, -1, v220
    s_nop 4
    s_cbranch_vccnz p_vh2
p_wh2:
    s_barrier
    ds_read_b64_tr_b16 v[136:137], v208 offset:32768
    ds_read_b64_tr_b16 v[224:225], v210 offset:0
    ds_read_b64_tr_b16 v[226:227], v210 offset:1024
    ds_read_b64_tr_b16 v[228:229], v210 offset:4096
    v_mfma_f32_32x32x16_bf16 v[80:95], a[212:215], v[148:151], v[80:95]
    ds_read_b64_tr_b16 v[138:139], v208 offset:33792
    buffer_load_dwordx4 a[160:163], v246, s[12:15], s26 offen offset:2048 sc1
    ds_read_b64_tr_b16 v[230:231], v210 offset:5120
    v_mfma_f32_32x32x16_bf16 v[32:47], a[208:211], v[152:155], v[32:47]
    ds_read_b64_tr_b16 v[140:141], v208 offset:33024
    v_mfma_f32_32x32x16_bf16 v[96:111], a[212:215], v[152:155], v[96:111]
    ds_read_b64_tr_b16 v[142:143], v208 offset:34048
    buffer_load_dwordx4 a[164:167], v247, s[12:15], s26 offen offset:2048 sc1
    v_mfma_f32_32x32x16_bf16 v[48:63], a[208:211], v[156:159], v[48:63]
    ds_read_b64_tr_b16 v[144:145], v208 offset:33280
    v_mfma_f32_32x32x16_bf16 v[112:127], a[212:215], v[156:159], v[112:127]
    ds_read_b64_tr_b16 v[146:147], v208 offset:34304
    buffer_load_dwordx4 a[168:171], v246, s[12:15], s26 offen offset:3072 sc1
    s_waitcnt lgkmcnt(8)
    v_lshlrev_b32 v214, 16, v224
    v_and_b32 v215, 0xffff0000, v224
    v_mfma_f32_32x32x16_bf16 v[0:15], a[216:219], v[160:163], v[0:15]
    ds_read_b64_tr_b16 v[148:149], v208 offset:33536
    v_mul_f32 v212, v214, v214
    v_mul_f32 v213, v215, v215
    v_lshlrev_b32 v214, 16, v225
    v_and_b32 v215, 0xffff0000, v225
    v_fmac_f32 v212, v214, v214
    v_mfma_f32_32x32x16_bf16 v[64:79], a[220:223], v[160:163], v[64:79]
    ds_read_b64_tr_b16 v[150:151], v208 offset:34560
    buffer_load_dwordx4 a[172:175], v247, s[12:15], s26 offen offset:3072 sc1
    v_fmac_f32 v213, v215, v215
    s_waitcnt lgkmcnt(9)
    v_lshlrev_b32 v214, 16, v226
    v_mfma_f32_32x32x16_bf16 v[16:31], a[216:219], v[164:167], v[16:31]
    ds_read_b64_tr_b16 v[152:153], v208 offset:36864
    v_and_b32 v215, 0xffff0000, v226
    v_fmac_f32 v212, v214, v214
    v_fmac_f32 v213, v215, v215
    v_lshlrev_b32 v214, 16, v227
    v_and_b32 v215, 0xffff0000, v227
    v_mfma_f32_32x32x16_bf16 v[80:95], a[220:223], v[164:167], v[80:95]
    ds_read_b64_tr_b16 v[154:155], v208 offset:37888
    buffer_load_dwordx4 a[176:179], v246, s[12:15], s27 offen offset:0 sc1
    v_fmac_f32 v212, v214, v214
    v_fmac_f32 v213, v215, v215
    v_mfma_f32_32x32x16_bf16 v[32:47], a[216:219], v[128:131], v[32:47]
    ds_read_b64_tr_b16 v[156:157], v208 offset:37120
    s_waitcnt lgkmcnt(11)
    v_lshlrev_b32 v214, 16, v228
    v_and_b32 v215, 0xffff0000, v228
    v_fmac_f32 v212, v214, v214
    v_fmac_f32 v213, v215, v215
    v_lshlrev_b32 v214, 16, v229
    v_mfma_f32_32x32x16_bf16 v[96:111], a[220:223], v[128:131], v[96:111]
    ds_read_b64_tr_b16 v[158:159], v208 offset:38144
    buffer_load_dwordx4 a[180:183], v247, s[12:15], s27 offen offset:0 sc1
    v_and_b32 v215, 0xffff0000, v229
    v_fmac_f32 v212, v214, v214
    v_mfma_f32_32x32x16_bf16 v[48:63], a[216:219], v[132:135], v[48:63]
    ds_read_b64_tr_b16 v[160:161], v208 offset:37376
    s_waitcnt vmcnt(18)
    ds_read2st64_b32 v[220:221], v241 offset0:192 offset1:196
    ds_read2st64_b32 v[222:223], v241 offset0:200 offset1:204
    v_fmac_f32 v213, v215, v215
    s_waitcnt lgkmcnt(13)
    v_lshlrev_b32 v214, 16, v230
    v_mfma_f32_32x32x16_bf16 v[112:127], a[220:223], v[132:135], v[112:127]
    ds_read_b64_tr_b16 v[162:163], v208 offset:38400
    buffer_load_dwordx4 a[184:187], v246, s[12:15], s27 offen offset:1024 sc1
    v_and_b32 v215, 0xffff0000, v230
    v_fmac_f32 v212, v214, v214
    v_mfma_f32_32x32x16_bf16 v[0:15], a[224:227], v[136:139], v[0:15]
    ds_read_b64_tr_b16 v[164:165], v208 offset:37632
    v_fmac_f32 v213, v215, v215
    v_lshlrev_b32 v214, 16, v231
    v_and_b32 v215, 0xffff0000, v231
    v_fmac_f32 v212, v214, v214
    v_fmac_f32 v213, v215, v215
    v_mfma_f32_32x32x16_bf16 v[64:79], a[228:231], v[136:139], v[64:79]
    ds_read_b64_tr_b16 v[166:167], v208 offset:38656
    buffer_load_dwordx4 a[188:191], v247, s[12:15], s27 offen offset:1024 sc1
    v_add_f32 v212, v212, v213
    v_mov_b32 v213, v212
    s_waitcnt lgkmcnt(14)
    v_mfma_f32_32x32x16_bf16 v[16:31], a[224:227], v[140:143], v[16:31]
    ds_read_b64_tr_b16 v[128:129], v208 offset:40960
    v_permlane32_swap_b32 v212, v213
    v_add_f32 v212, v212, v213
    v_mfma_f32_32x32x16_bf16 v[80:95], a[228:231], v[140:143], v[80:95]
    ds_read_b64_tr_b16 v[130:131], v208 offset:41984
    s_mov_b32 m0, s9
    s_add_u32 s9, s9, 16384
    buffer_load_dwordx4 v204, s[12:15], s8 offen offset:0 sc1 lds
    s_waitcnt lgkmcnt(14)
    v_mfma_f32_32x32x16_bf16 v[32:47], a[224:227], v[144:147], v[32:47]
    ds_read_b64_tr_b16 v[132:133], v208 offset:41216
    s_waitcnt lgkmcnt(6)
    v_max3_u32 v220, v220, v221, v222
    v_max_u32 v220, v220, v223
    v_cmp_eq_u32 vcc, -1, v220
    s_nop 4
    s_cbranch_vccnz p_vh3
p_wh3:
    v_mfma_f32_32x32x16_bf16 v[96:111], a[228:231], v[144:147], v[96:111]
    ds_read_b64_tr_b16 v[134:135], v208 offset:42240
    buffer_load_dwordx4 v205, s[12:15], s8 offen offset:1024 sc1 lds
    buffer_store_dword v212, v232, s[12:15], s41 offen sc1
    v_mfma_f32_32x32x16_bf16 v[48:63], a[224:227], v[148:151], v[48:63]
    ds_read_b64_tr_b16 v[136:137], v208 offset:41472
    v_mfma_f32_32x32x16_bf16 v[112:127], a[228:231], v[148:151], v[112:127]
    ds_read_b64_tr_b16 v[138:139], v208 offset:42496
    v_mfma_f32_32x32x16_bf16 v[0:15], a[232:235], v[152:155], v[0:15]
    ds_read_b64_tr_b16 v[140:141], v208 offset:41728
    v_mfma_f32_32x32x16_bf16 v[64:79], a[236:239], v[152:155], v[64:79]
    ds_read_b64_tr_b16 v[142:143], v208 offset:42752
    buffer_load_dwordx4 v206, s[12:15], s8 offen offset:2048 sc1 lds
    v_mfma_f32_32x32x16_bf16 v[16:31], a[232:235], v[156:159], v[16:31]
    ds_read_b64_tr_b16 v[144:145], v208 offset:45056
    v_mfma_f32_32x32x16_bf16 v[80:95], a[236:239], v[156:159], v[80:95]
    ds_read_b64_tr_b16 v[146:147], v208 offset:46080
    buffer_load_dwordx4 v207, s[12:15], s8 offen offset:3072 sc1 lds
    s_add_u32 s8, s8, 278528
    s_waitcnt lgkmcnt(12)
    v_mfma_f32_32x32x16_bf16 v[32:47], a[232:235], v[160:163], v[32:47]
    ds_read_b64_tr_b16 v[148:149], v208 offset:45312
    v_mfma_f32_32x32x16_bf16 v[96:111], a[236:239], v[160:163], v[96:111]
    ds_read_b64_tr_b16 v[150:151], v208 offset:46336
    buffer_load_dwordx4 a[192:195], v246, s[12:15], s27 offen offset:2048 sc1
    s_waitcnt lgkmcnt(12)
    v_mfma_f32_32x32x16_bf16 v[48:63], a[232:235], v[164:167], v[48:63]
    ds_read_b64_tr_b16 v[152:153], v208 offset:45568
    v_mfma_f32_32x32x16_bf16 v[112:127], a[236:239], v[164:167], v[112:127]
    ds_read_b64_tr_b16 v[154:155], v208 offset:46592
    buffer_load_dwordx4 a[196:199], v247, s[12:15], s27 offen offset:2048 sc1
    s_waitcnt lgkmcnt(12)
    s_waitcnt vmcnt(26)
    v_mfma_f32_32x32x16_bf16 v[0:15], a[240:243], v[128:131], v[0:15]
    ds_read_b64_tr_b16 v[156:157], v208 offset:45824
    s_waitcnt vmcnt(25)
    v_mfma_f32_32x32x16_bf16 v[64:79], a[244:247], v[128:131], v[64:79]
    ds_read_b64_tr_b16 v[158:159], v208 offset:46848
    buffer_load_dwordx4 a[200:203], v246, s[12:15], s27 offen offset:3072 sc1
    s_waitcnt lgkmcnt(12)
    v_mfma_f32_32x32x16_bf16 v[16:31], a[240:243], v[132:135], v[16:31]
    s_barrier
    ds_read_b64_tr_b16 v[160:161], v208 offset:49152
    v_mfma_f32_32x32x16_bf16 v[80:95], a[244:247], v[132:135], v[80:95]
    ds_read_b64_tr_b16 v[162:163], v208 offset:50176
    buffer_load_dwordx4 a[204:207], v247, s[12:15], s27 offen offset:3072 sc1
    s_waitcnt lgkmcnt(12)
    v_mfma_f32_32x32x16_bf16 v[32:47], a[240:243], v[136:139], v[32:47]
    ds_read_b64_tr_b16 v[164:165], v208 offset:49408
    v_mfma_f32_32x32x16_bf16 v[96:111], a[244:247], v[136:139], v[96:111]
    ds_read_b64_tr_b16 v[166:167], v208 offset:50432
    s_mov_b32 m0, s9
    s_add_u32 s9, s9, 16384
    buffer_load_dwordx4 v204, s[12:15], s8 offen offset:0 sc1 lds
    s_waitcnt lgkmcnt(12)
    v_mfma_f32_32x32x16_bf16 v[48:63], a[240:243], v[140:143], v[48:63]
    ds_read_b64_tr_b16 v[128:129], v208 offset:49664
    s_waitcnt vmcnt(18)
    ds_read2st64_b32 v[220:221], v242 offset0:0 offset1:4
    ds_read2st64_b32 v[222:223], v242 offset0:8 offset1:12
    v_mfma_f32_32x32x16_bf16 v[112:127], a[244:247], v[140:143], v[112:127]
    ds_read_b64_tr_b16 v[130:131], v208 offset:50688
    buffer_load_dwordx4 v205, s[12:15], s8 offen offset:1024 sc1 lds
    s_waitcnt lgkmcnt(14)
    v_mfma_f32_32x32x16_bf16 v[0:15], a[248:251], v[144:147], v[0:15]
    ds_read_b64_tr_b16 v[132:133], v208 offset:49920
    v_mfma_f32_32x32x16_bf16 v[64:79], a[252:255], v[144:147], v[64:79]
    ds_read_b64_tr_b16 v[134:135], v208 offset:50944
    buffer_load_dwordx4 v206, s[12:15], s8 offen offset:2048 sc1 lds
    s_waitcnt lgkmcnt(14)
    v_mfma_f32_32x32x16_bf16 v[16:31], a[248:251], v[148:151], v[16:31]
    ds_read_b64_tr_b16 v[136:137], v208 offset:53248
    v_mfma_f32_32x32x16_bf16 v[80:95], a[252:255], v[148:151], v[80:95]
    ds_read_b64_tr_b16 v[138:139], v208 offset:54272
    buffer_load_dwordx4 v207, s[12:15], s8 offen offset:3072 sc1 lds
    s_add_u32 s8, s8, 278528
    s_waitcnt lgkmcnt(14)
    v_mfma_f32_32x32x16_bf16 v[32:47], a[248:251], v[152:155], v[32:47]
    ds_read_b64_tr_b16 v[140:141], v208 offset:53504
    s_waitcnt lgkmcnt(6)
    v_max3_u32 v220, v220, v221, v222
    v_max_u32 v220, v220, v223
    v_cmp_eq_u32 vcc, -1, v220
    s_nop 4
    s_cbranch_vccnz p_vh4
p_wh4:
    v_mfma_f32_32x32x16_bf16 v[96:111], a[252:255], v[152:155], v[96:111]
    ds_read_b64_tr_b16 v[142:143], v208 offset:54528
    buffer_load_dwordx4 a[208:211], v246, s[12:15], s32 offen offset:0 sc1
    v_mfma_f32_32x32x16_bf16 v[48:63], a[248:251], v[156:159], v[48:63]
    ds_read_b64_tr_b16 v[144:145], v208 offset:53760
    v_mfma_f32_32x32x16_bf16 v[112:127], a[252:255], v[156:159], v[112:127]
    ds_read_b64_tr_b16 v[146:147], v208 offset:54784
    buffer_load_dwordx4 a[212:215], v247, s[12:15], s32 offen offset:0 sc1
    v_mfma_f32_32x32x16_bf16 v[0:15], v[184:187], v[160:163], v[0:15]
    ds_read_b64_tr_b16 v[148:149], v208 offset:54016
    v_mfma_f32_32x32x16_bf16 v[64:79], v[188:191], v[160:163], v[64:79]
    ds_read_b64_tr_b16 v[150:151], v208 offset:55040
    s_mov_b32 m0, s9
    s_add_u32 s9, s9, 16384
    buffer_load_dwordx4 v204, s[12:15], s8 offen offset:0 sc1 lds
    v_mfma_f32_32x32x16_bf16 v[16:31], v[184:187], v[164:167], v[16:31]
    ds_read_b64_tr_b16 v[152:153], v208 offset:57344
    v_mfma_f32_32x32x16_bf16 v[80:95], v[188:191], v[164:167], v[80:95]
    ds_read_b64_tr_b16 v[154:155], v208 offset:58368
    buffer_load_dwordx4 v205, s[12:15], s8 offen offset:1024 sc1 lds
    s_waitcnt lgkmcnt(12)
    v_mfma_f32_32x32x16_bf16 v[32:47], v[184:187], v[128:131], v[32:47]
    ds_read_b64_tr_b16 v[156:157], v208 offset:57600
    v_mfma_f32_32x32x16_bf16 v[96:111], v[188:191], v[128:131], v[96:111]
    ds_read_b64_tr_b16 v[158:159], v208 offset:58624
    buffer_load_dwordx4 v206, s[12:15], s8 offen offset:2048 sc1 lds
    s_waitcnt lgkmcnt(12)
    v_mfma_f32_32x32x16_bf16 v[48:63], v[184:187], v[132:135], v[48:63]
    ds_read_b64_tr_b16 v[160:161], v208 offset:57856
    v_mfma_f32_32x32x16_bf16 v[112:127], v[188:191], v[132:135], v[112:127]
    ds_read_b64_tr_b16 v[162:163], v208 offset:58880
    buffer_load_dwordx4 v207, s[12:15], s8 offen offset:3072 sc1 lds
    s_add_u32 s8, s8, 278528
    s_waitcnt lgkmcnt(12)
    v_mfma_f32_32x32x16_bf16 v[0:15], v[192:195], v[136:139], v[0:15]
    ds_read_b64_tr_b16 v[164:165], v208 offset:58112
    v_mfma_f32_32x32x16_bf16 v[64:79], v[196:199], v[136:139], v[64:79]
    ds_read_b64_tr_b16 v[166:167], v208 offset:59136
    buffer_load_dwordx4 a[216:219], v246, s[12:15], s32 offen offset:1024 sc1
    s_waitcnt lgkmcnt(12)
    v_mfma_f32_32x32x16_bf16 v[16:31], v[192:195], v[140:143], v[16:31]
    ds_read_b64_tr_b16 v[128:129], v208 offset:61440
    v_mfma_f32_32x32x16_bf16 v[80:95], v[196:199], v[140:143], v[80:95]
    ds_read_b64_tr_b16 v[130:131], v208 offset:62464
    buffer_load_dwordx4 a[220:223], v247, s[12:15], s32 offen offset:1024 sc1
    s_waitcnt lgkmcnt(12)
    v_mfma_f32_32x32x16_bf16 v[32:47], v[192:195], v[144:147], v[32:47]
    ds_read_b64_tr_b16 v[132:133], v208 offset:61696
    v_mfma_f32_32x32x16_bf16 v[96:111], v[196:199], v[144:147], v[96:111]
    ds_read_b64_tr_b16 v[134:135], v208 offset:62720
    buffer_load_dwordx4 a[224:227], v246, s[12:15], s32 offen offset:2048 sc1
    s_waitcnt lgkmcnt(12)
    v_mfma_f32_32x32x16_bf16 v[48:63], v[192:195], v[148:151], v[48:63]
    ds_read_b64_tr_b16 v[136:137], v208 offset:61952
    v_mfma_f32_32x32x16_bf16 v[112:127], v[196:199], v[148:151], v[112:127]
    ds_read_b64_tr_b16 v[138:139], v208 offset:62976
    buffer_load_dwordx4 a[228:231], v247, s[12:15], s32 offen offset:2048 sc1
    s_waitcnt lgkmcnt(12)
    s_waitcnt vmcnt(30)
    v_mfma_f32_32x32x16_bf16 v[0:15], a[160:163], v[152:155], v[0:15]
    ds_read_b64_tr_b16 v[140:141], v208 offset:62208
    s_waitcnt vmcnt(18)
    ds_read2st64_b32 v[220:221], v242 offset0:64 offset1:68
    ds_read2st64_b32 v[222:223], v242 offset0:72 offset1:76
    v_mfma_f32_32x32x16_bf16 v[64:79], a[164:167], v[152:155], v[64:79]
    ds_read_b64_tr_b16 v[142:143], v208 offset:63232
    buffer_load_dwordx4 a[232:235], v246, s[12:15], s32 offen offset:3072 sc1
    s_waitcnt lgkmcnt(14)
    v_mfma_f32_32x32x16_bf16 v[16:31], a[160:163], v[156:159], v[16:31]
    s_barrier
    ds_read_b64_tr_b16 v[144:145], v209 offset:0
    v_mfma_f32_32x32x16_bf16 v[80:95], a[164:167], v[156:159], v[80:95]
    ds_read_b64_tr_b16 v[146:147], v209 offset:1024
    buffer_load_dwordx4 a[236:239], v247, s[12:15], s32 offen offset:3072 sc1
    s_waitcnt lgkmcnt(14)
    v_mfma_f32_32x32x16_bf16 v[32:47], a[160:163], v[160:163], v[32:47]
    ds_read_b64_tr_b16 v[148:149], v209 offset:256
    v_mfma_f32_32x32x16_bf16 v[96:111], a[164:167], v[160:163], v[96:111]
    ds_read_b64_tr_b16 v[150:151], v209 offset:1280
    buffer_load_dwordx4 a[240:243], v246, s[12:15], s33 offen offset:0 sc1
    s_waitcnt lgkmcnt(14)
    v_mfma_f32_32x32x16_bf16 v[48:63], a[160:163], v[164:167], v[48:63]
    ds_read_b64_tr_b16 v[152:153], v209 offset:512
    s_waitcnt lgkmcnt(6)
    v_max3_u32 v220, v220, v221, v222
    v_max_u32 v220, v220, v223
    v_cmp_eq_u32 vcc, -1, v220
    s_nop 4
    s_cbranch_vccnz p_vh5
p_wh5:
    v_mfma_f32_32x32x16_bf16 v[112:127], a[164:167], v[164:167], v[112:127]
    ds_read_b64_tr_b16 v[154:155], v209 offset:1536
    buffer_load_dwordx4 a[244:247], v247, s[12:15], s33 offen offset:0 sc1
    v_mfma_f32_32x32x16_bf16 v[0:15], a[168:171], v[128:131], v[0:15]
    ds_read_b64_tr_b16 v[156:157], v209 offset:768
    v_mfma_f32_32x32x16_bf16 v[64:79], a[172:175], v[128:131], v[64:79]
    ds_read_b64_tr_b16 v[158:159], v209 offset:1792
    buffer_load_dwordx4 a[248:251], v246, s[12:15], s33 offen offset:1024 sc1
    v_mfma_f32_32x32x16_bf16 v[16:31], a[168:171], v[132:135], v[16:31]
    ds_read_b64_tr_b16 v[160:161], v209 offset:4096
    v_mfma_f32_32x32x16_bf16 v[80:95], a[172:175], v[132:135], v[80:95]
    ds_read_b64_tr_b16 v[162:163], v209 offset:5120
    buffer_load_dwordx4 a[252:255], v247, s[12:15], s33 offen offset:1024 sc1
    v_mfma_f32_32x32x16_bf16 v[32:47], a[168:171], v[136:139], v[32:47]
    ds_read_b64_tr_b16 v[164:165], v209 offset:4352
    v_mfma_f32_32x32x16_bf16 v[96:111], a[172:175], v[136:139], v[96:111]
    ds_read_b64_tr_b16 v[166:167], v209 offset:5376
    buffer_load_dwordx4 v[184:187], v246, s[12:15], s33 offen offset:2048 sc1
    s_waitcnt lgkmcnt(12)
    v_mfma_f32_32x32x16_bf16 v[48:63], a[168:171], v[140:143], v[48:63]
    ds_read_b64_tr_b16 v[128:129], v209 offset:4608
    v_mfma_f32_32x32x16_bf16 v[112:127], a[172:175], v[140:143], v[112:127]
    ds_read_b64_tr_b16 v[130:131], v209 offset:5632
    buffer_load_dwordx4 v[188:191], v247, s[12:15], s33 offen offset:2048 sc1
    s_waitcnt lgkmcnt(12)
    v_mfma_f32_32x32x16_bf16 v[0:15], a[176:179], v[144:147], v[0:15]
    ds_read_b64_tr_b16 v[132:133], v209 offset:4864
    s_waitcnt vmcnt(18)
    ds_read2st64_b32 v[220:221], v242 offset0:128 offset1:132
    ds_read2st64_b32 v[222:223], v242 offset0:136 offset1:140
    v_mfma_f32_32x32x16_bf16 v[64:79], a[180:183], v[144:147], v[64:79]
    ds_read_b64_tr_b16 v[134:135], v209 offset:5888
    buffer_load_dwordx4 v[192:195], v246, s[12:15], s33 offen offset:3072 sc1
    s_waitcnt lgkmcnt(14)
    v_mfma_f32_32x32x16_bf16 v[16:31], a[176:179], v[148:151], v[16:31]
    ds_read_b64_tr_b16 v[136:137], v209 offset:8192
    v_mfma_f32_32x32x16_bf16 v[80:95], a[180:183], v[148:151], v[80:95]
    ds_read_b64_tr_b16 v[138:139], v209 offset:9216
    buffer_load_dwordx4 v[196:199], v247, s[12:15], s33 offen offset:3072 sc1
    s_waitcnt lgkmcnt(14)
    v_mfma_f32_32x32x16_bf16 v[32:47], a[176:179], v[152:155], v[32:47]
    ds_read_b64_tr_b16 v[140:141], v209 offset:8448
    v_mfma_f32_32x32x16_bf16 v[96:111], a[180:183], v[152:155], v[96:111]
    ds_read_b64_tr_b16 v[142:143], v209 offset:9472
    buffer_load_dwordx4 a[160:163], v246, s[12:15], s34 offen offset:0 sc1
    s_waitcnt lgkmcnt(14)
    v_mfma_f32_32x32x16_bf16 v[48:63], a[176:179], v[156:159], v[48:63]
    ds_read_b64_tr_b16 v[144:145], v209 offset:8704
    s_waitcnt lgkmcnt(6)
    v_max3_u32 v220, v220, v221, v222
    v_max_u32 v220, v220, v223
    v_cmp_eq_u32 vcc, -1, v220
    s_nop 4
    s_cbranch_vccnz p_vh6
p_wh6:
    v_mfma_f32_32x32x16_bf16 v[112:127], a[180:183], v[156:159], v[112:127]
    ds_read_b64_tr_b16 v[146:147], v209 offset:9728
    buffer_load_dwordx4 a[164:167], v247, s[12:15], s34 offen offset:0 sc1
    v_mfma_f32_32x32x16_bf16 v[0:15], a[184:187], v[160:163], v[0:15]
    ds_read_b64_tr_b16 v[148:149], v209 offset:8960
    v_mfma_f32_32x32x16_bf16 v[64:79], a[188:191], v[160:163], v[64:79]
    ds_read_b64_tr_b16 v[150:151], v209 offset:9984
    buffer_load_dwordx4 a[168:171], v246, s[12:15], s34 offen offset:1024 sc1
    v_mfma_f32_32x32x16_bf16 v[16:31], a[184:187], v[164:167], v[16:31]
    ds_read_b64_tr_b16 v[152:153], v209 offset:12288
    v_mfma_f32_32x32x16_bf16 v[80:95], a[188:191], v[164:167], v[80:95]
    ds_read_b64_tr_b16 v[154:155], v209 offset:13312
    buffer_load_dwordx4 a[172:175], v247, s[12:15], s34 offen offset:1024 sc1
    v_mfma_f32_32x32x16_bf16 v[32:47], a[184:187], v[128:131], v[32:47]
    ds_read_b64_tr_b16 v[156:157], v209 offset:12544
    s_waitcnt vmcnt(18)
    ds_read2st64_b32 v[220:221], v242 offset0:192 offset1:196
    ds_read2st64_b32 v[222:223], v242 offset0:200 offset1:204
    v_mfma_f32_32x32x16_bf16 v[96:111], a[188:191], v[128:131], v[96:111]
    ds_read_b64_tr_b16 v[158:159], v209 offset:13568
    buffer_load_dwordx4 a[176:179], v246, s[12:15], s34 offen offset:2048 sc1
    s_waitcnt lgkmcnt(14)
    v_mfma_f32_32x32x16_bf16 v[48:63], a[184:187], v[132:135], v[48:63]
    ds_read_b64_tr_b16 v[160:161], v209 offset:12800
    v_mfma_f32_32x32x16_bf16 v[112:127], a[188:191], v[132:135], v[112:127]
    ds_read_b64_tr_b16 v[162:163], v209 offset:13824
    buffer_load_dwordx4 a[180:183], v247, s[12:15], s34 offen offset:2048 sc1
    s_waitcnt lgkmcnt(14)
    v_mfma_f32_32x32x16_bf16 v[0:15], a[192:195], v[136:139], v[0:15]
    ds_read_b64_tr_b16 v[164:165], v209 offset:13056
    v_mfma_f32_32x32x16_bf16 v[64:79], a[196:199], v[136:139], v[64:79]
    ds_read_b64_tr_b16 v[166:167], v209 offset:14080
    buffer_load_dwordx4 a[184:187], v246, s[12:15], s34 offen offset:3072 sc1
    s_waitcnt lgkmcnt(14)
    v_mfma_f32_32x32x16_bf16 v[16:31], a[192:195], v[140:143], v[16:31]
    s_barrier
    ds_read_b64_tr_b16 v[128:129], v209 offset:16384
    v_mfma_f32_32x32x16_bf16 v[80:95], a[196:199], v[140:143], v[80:95]
    ds_read_b64_tr_b16 v[130:131], v209 offset:17408
    buffer_load_dwordx4 a[188:191], v247, s[12:15], s34 offen offset:3072 sc1
    s_waitcnt lgkmcnt(14)
    v_mfma_f32_32x32x16_bf16 v[32:47], a[192:195], v[144:147], v[32:47]
    ds_read_b64_tr_b16 v[132:133], v209 offset:16640
    s_waitcnt lgkmcnt(8)
    v_max3_u32 v220, v220, v221, v222
    v_max_u32 v220, v220, v223
    v_cmp_eq_u32 vcc, -1, v220
    s_nop 4
    s_cbranch_vccnz p_vh7
p_wh7:
    v_mfma_f32_32x32x16_bf16 v[96:111], a[196:199], v[144:147], v[96:111]
    ds_read_b64_tr_b16 v[134:135], v209 offset:17664
    v_mfma_f32_32x32x16_bf16 v[48:63], a[192:195], v[148:151], v[48:63]
    ds_read_b64_tr_b16 v[136:137], v209 offset:16896
    s_lshl_b32 s47, s54, 4
    s_add_u32 s47, s47, 32768
    s_add_u32 m0, s35, 0
    s_nop 0
    buffer_load_dwordx4 v250, s[28:31], s47 offen offset:0  lds
    v_mfma_f32_32x32x16_bf16 v[112:127], a[196:199], v[148:151], v[112:127]
    ds_read_b64_tr_b16 v[138:139], v209 offset:17920
    v_mfma_f32_32x32x16_bf16 v[0:15], a[200:203], v[152:155], v[0:15]
    ds_read_b64_tr_b16 v[140:141], v209 offset:17152
    buffer_load_dwordx4 v251, s[28:31], s47 offen offset:1024  lds
    v_mfma_f32_32x32x16_bf16 v[64:79], a[204:207], v[152:155], v[64:79]
    ds_read_b64_tr_b16 v[142:143], v209 offset:18176
    s_waitcnt lgkmcnt(12)
    v_mfma_f32_32x32x16_bf16 v[16:31], a[200:203], v[156:159], v[16:31]
    ds_read_b64_tr_b16 v[144:145], v209 offset:20480
    buffer_load_dwordx4 v252, s[28:31], s47 offen offset:2048  lds
    v_mfma_f32_32x32x16_bf16 v[80:95], a[204:207], v[156:159], v[80:95]
    ds_read_b64_tr_b16 v[146:147], v209 offset:21504
    s_waitcnt lgkmcnt(12)
    v_mfma_f32_32x32x16_bf16 v[32:47], a[200:203], v[160:163], v[32:47]
    ds_read_b64_tr_b16 v[148:149], v209 offset:20736
    buffer_load_dwordx4 v253, s[28:31], s47 offen offset:3072  lds
    v_mfma_f32_32x32x16_bf16 v[96:111], a[204:207], v[160:163], v[96:111]
    ds_read_b64_tr_b16 v[150:151], v209 offset:21760
    s_waitcnt lgkmcnt(12)
    v_mfma_f32_32x32x16_bf16 v[48:63], a[200:203], v[164:167], v[48:63]
    ds_read_b64_tr_b16 v[152:153], v209 offset:20992
    v_mfma_f32_32x32x16_bf16 v[112:127], a[204:207], v[164:167], v[112:127]
    ds_read_b64_tr_b16 v[154:155], v209 offset:22016
    s_waitcnt lgkmcnt(12)
    v_mfma_f32_32x32x16_bf16 v[0:15], a[208:211], v[128:131], v[0:15]
    ds_read_b64_tr_b16 v[156:157], v209 offset:21248
    v_mfma_f32_32x32x16_bf16 v[64:79], a[212:215], v[128:131], v[64:79]
    ds_read_b64_tr_b16 v[158:159], v209 offset:22272
    s_waitcnt lgkmcnt(12)
    v_mfma_f32_32x32x16_bf16 v[16:31], a[208:211], v[132:135], v[16:31]
    ds_read_b64_tr_b16 v[160:161], v209 offset:24576
    v_mfma_f32_32x32x16_bf16 v[80:95], a[212:215], v[132:135], v[80:95]
    ds_read_b64_tr_b16 v[162:163], v209 offset:25600
    s_barrier
    s_waitcnt lgkmcnt(12)
    v_mfma_f32_32x32x16_bf16 v[32:47], a[208:211], v[136:139], v[32:47]
    ds_read_b64_tr_b16 v[164:165], v209 offset:28672
    s_lshl_b32 s47, s52, 4
    s_add_u32 m0, s99, 0
    s_nop 0
    buffer_load_dwordx4 v250, s[28:31], s47 offen offset:0  lds
    v_mfma_f32_32x32x16_bf16 v[96:111], a[212:215], v[136:139], v[96:111]
    ds_read_b64_tr_b16 v[166:167], v209 offset:29696
    s_waitcnt lgkmcnt(12)
    v_mfma_f32_32x32x16_bf16 v[48:63], a[208:211], v[140:143], v[48:63]
    ds_read_b64_tr_b16 v[128:129], v209 offset:32768
    buffer_load_dwordx4 v251, s[28:31], s47 offen offset:1024  lds
    v_mfma_f32_32x32x16_bf16 v[112:127], a[212:215], v[140:143], v[112:127]
    ds_read_b64_tr_b16 v[130:131], v209 offset:33792
    s_waitcnt lgkmcnt(12)
    s_waitcnt vmcnt(27)
    v_mfma_f32_32x32x16_bf16 v[0:15], a[216:219], v[144:147], v[0:15]
    ds_read_b64_tr_b16 v[132:133], v209 offset:36864
    buffer_load_dwordx4 v252, s[28:31], s47 offen offset:2048  lds
    s_waitcnt vmcnt(27)
    v_mfma_f32_32x32x16_bf16 v[64:79], a[220:223], v[144:147], v[64:79]
    ds_read_b64_tr_b16 v[134:135], v209 offset:37888
    s_waitcnt lgkmcnt(12)
    v_mfma_f32_32x32x16_bf16 v[16:31], a[216:219], v[148:151], v[16:31]
    ds_read_b64_tr_b16 v[136:137], v209 offset:40960
    buffer_load_dwordx4 v253, s[28:31], s47 offen offset:3072  lds
    v_mfma_f32_32x32x16_bf16 v[80:95], a[220:223], v[148:151], v[80:95]
    ds_read_b64_tr_b16 v[138:139], v209 offset:41984
    s_waitcnt lgkmcnt(12)
    v_mfma_f32_32x32x16_bf16 v[32:47], a[216:219], v[152:155], v[32:47]
    ds_read_b64_tr_b16 v[140:141], v209 offset:45056
    s_lshl_b32 s47, s52, 4
    s_add_u32 s47, s47, 32768
    s_add_u32 m0, s99, 4096
    s_nop 0
    buffer_load_dwordx4 v250, s[28:31], s47 offen offset:0  lds
    v_mfma_f32_32x32x16_bf16 v[96:111], a[220:223], v[152:155], v[96:111]
    ds_read_b64_tr_b16 v[142:143], v209 offset:46080
    s_waitcnt lgkmcnt(12)
    v_mfma_f32_32x32x16_bf16 v[48:63], a[216:219], v[156:159], v[48:63]
    s_barrier
    ds_read_b64_tr_b16 v[144:145], v209 offset:49152
    buffer_load_dwordx4 v251, s[28:31], s47 offen offset:1024  lds
    v_mfma_f32_32x32x16_bf16 v[112:127], a[220:223], v[156:159], v[112:127]
    ds_read_b64_tr_b16 v[146:147], v209 offset:50176
    s_waitcnt lgkmcnt(12)
    s_waitcnt vmcnt(29)
    v_mfma_f32_32x32x16_bf16 v[0:15], a[224:227], v[160:163], v[0:15]
    ds_read_b64_tr_b16 v[148:149], v209 offset:53248
    buffer_load_dwordx4 v252, s[28:31], s47 offen offset:2048  lds
    s_waitcnt vmcnt(29)
    v_mfma_f32_32x32x16_bf16 v[64:79], a[228:231], v[160:163], v[64:79]
    ds_read_b64_tr_b16 v[150:151], v209 offset:54272
    s_waitcnt lgkmcnt(12)
    s_waitcnt vmcnt(28)
    v_mfma_f32_32x32x16_bf16 v[0:15], a[232:235], v[164:167], v[0:15]
    ds_read_b64_tr_b16 v[152:153], v209 offset:57344
    buffer_load_dwordx4 v253, s[28:31], s47 offen offset:3072  lds
    s_waitcnt vmcnt(28)
    v_mfma_f32_32x32x16_bf16 v[64:79], a[236:239], v[164:167], v[64:79]
    ds_read_b64_tr_b16 v[154:155], v209 offset:58368
    s_waitcnt lgkmcnt(12)
    s_waitcnt vmcnt(27)
    v_mfma_f32_32x32x16_bf16 v[0:15], a[240:243], v[128:131], v[0:15]
    ds_read_b64_tr_b16 v[156:157], v209 offset:61440
    s_lshl_b32 s47, s53, 4
    s_add_u32 m0, s99, 8192
    s_nop 0
    buffer_load_dwordx4 v250, s[28:31], s47 offen offset:0  lds
    s_waitcnt vmcnt(27)
    v_mfma_f32_32x32x16_bf16 v[64:79], a[244:247], v[128:131], v[64:79]
    ds_read_b64_tr_b16 v[158:159], v209 offset:62464
    s_waitcnt lgkmcnt(12)
    s_waitcnt vmcnt(26)
    v_mfma_f32_32x32x16_bf16 v[0:15], a[248:251], v[132:135], v[0:15]
    ds_read_b64_tr_b16 v[160:161], v209 offset:24832
    buffer_load_dwordx4 v251, s[28:31], s47 offen offset:1024  lds
    s_waitcnt vmcnt(26)
    v_mfma_f32_32x32x16_bf16 v[64:79], a[252:255], v[132:135], v[64:79]
    ds_read_b64_tr_b16 v[162:163], v209 offset:25856
    s_waitcnt lgkmcnt(12)
    s_waitcnt vmcnt(25)
    v_mfma_f32_32x32x16_bf16 v[0:15], v[184:187], v[136:139], v[0:15]
    ds_read_b64_tr_b16 v[164:165], v209 offset:28928
    buffer_load_dwordx4 v252, s[28:31], s47 offen offset:2048  lds
    s_waitcnt vmcnt(25)
    v_mfma_f32_32x32x16_bf16 v[64:79], v[188:191], v[136:139], v[64:79]
    ds_read_b64_tr_b16 v[166:167], v209 offset:29952
    s_waitcnt lgkmcnt(12)
    s_waitcnt vmcnt(24)
    v_mfma_f32_32x32x16_bf16 v[0:15], v[192:195], v[140:143], v[0:15]
    ds_read_b64_tr_b16 v[128:129], v209 offset:33024
    buffer_load_dwordx4 v253, s[28:31], s47 offen offset:3072  lds
    s_waitcnt vmcnt(24)
    v_mfma_f32_32x32x16_bf16 v[64:79], v[196:199], v[140:143], v[64:79]
    ds_read_b64_tr_b16 v[130:131], v209 offset:34048
    s_waitcnt lgkmcnt(12)
    s_waitcnt vmcnt(23)
    v_mfma_f32_32x32x16_bf16 v[0:15], a[160:163], v[144:147], v[0:15]
    ds_read_b64_tr_b16 v[132:133], v209 offset:37120
    s_lshl_b32 s47, s53, 4
    s_add_u32 s47, s47, 32768
    s_add_u32 m0, s99, 12288
    s_nop 0
    buffer_load_dwordx4 v250, s[28:31], s47 offen offset:0  lds
    s_waitcnt vmcnt(23)
    v_mfma_f32_32x32x16_bf16 v[64:79], a[164:167], v[144:147], v[64:79]
    ds_read_b64_tr_b16 v[134:135], v209 offset:38144
    s_waitcnt lgkmcnt(12)
    s_waitcnt vmcnt(22)
    v_mfma_f32_32x32x16_bf16 v[0:15], a[168:171], v[148:151], v[0:15]
    ds_read_b64_tr_b16 v[136:137], v209 offset:41216
    buffer_load_dwordx4 v251, s[28:31], s47 offen offset:1024  lds
    s_waitcnt vmcnt(22)
    v_mfma_f32_32x32x16_bf16 v[64:79], a[172:175], v[148:151], v[64:79]
    ds_read_b64_tr_b16 v[138:139], v209 offset:42240
    s_waitcnt lgkmcnt(12)
    s_waitcnt vmcnt(21)
    v_mfma_f32_32x32x16_bf16 v[0:15], a[176:179], v[152:155], v[0:15]
    ds_read_b64_tr_b16 v[140:141], v209 offset:45312
    buffer_load_dwordx4 v252, s[28:31], s47 offen offset:2048  lds
    s_waitcnt vmcnt(21)
    v_mfma_f32_32x32x16_bf16 v[64:79], a[180:183], v[152:155], v[64:79]
    ds_read_b64_tr_b16 v[142:143], v209 offset:46336
    s_waitcnt lgkmcnt(12)
    s_waitcnt vmcnt(20)
    v_mfma_f32_32x32x16_bf16 v[0:15], a[184:187], v[156:159], v[0:15]
    ds_read_b64_tr_b16 v[144:145], v209 offset:49408
    buffer_load_dwordx4 v253, s[28:31], s47 offen offset:3072  lds
    s_waitcnt vmcnt(20)
    v_mfma_f32_32x32x16_bf16 v[64:79], a[188:191], v[156:159], v[64:79]
    ds_read_b64_tr_b16 v[146:147], v209 offset:50432
    s_waitcnt lgkmcnt(12)
    v_mfma_f32_32x32x16_bf16 v[16:31], a[224:227], v[160:163], v[16:31]
    ds_read_b64_tr_b16 v[148:149], v209 offset:53504
    s_lshl_b32 s47, s54, 4
    s_add_u32 m0, s99, 16384
    s_nop 0
    buffer_load_dwordx4 v250, s[28:31], s47 offen offset:0  lds
    v_mfma_f32_32x32x16_bf16 v[80:95], a[228:231], v[160:163], v[80:95]
    ds_read_b64_tr_b16 v[150:151], v209 offset:54528
    s_waitcnt lgkmcnt(12)
    v_mfma_f32_32x32x16_bf16 v[16:31], a[232:235], v[164:167], v[16:31]
    ds_read_b64_tr_b16 v[152:153], v209 offset:57600
    buffer_load_dwordx4 v251, s[28:31], s47 offen offset:1024  lds
    v_add_f32 v0, v0, v216
    v_add_f32 v1, v1, v216
    v_add_f32 v2, v2, v216
    v_add_f32 v3, v3, v216
    v_add_f32 v4, v4, v216
    v_mfma_f32_32x32x16_bf16 v[80:95], a[236:239], v[164:167], v[80:95]
    ds_read_b64_tr_b16 v[154:155], v209 offset:58624
    v_add_f32 v5, v5, v216
    v_add_f32 v6, v6, v216
    v_add_f32 v7, v7, v216
    v_cvt_pk_bf16_f32 v168, v0, v1
    v_cvt_pk_bf16_f32 v169, v2, v3
    v_cvt_pk_bf16_f32 v170, v4, v5
    s_waitcnt lgkmcnt(12)
    v_mfma_f32_32x32x16_bf16 v[16:31], a[240:243], v[128:131], v[16:31]
    ds_read_b64_tr_b16 v[156:157], v209 offset:61696
    buffer_load_dwordx4 v252, s[28:31], s47 offen offset:2048  lds
    v_cvt_pk_bf16_f32 v171, v6, v7
    buffer_store_dwordx4 v[168:171], v201, s[12:15], s43 offen offset:0 sc1
    v_add_f32 v8, v8, v216
    v_add_f32 v9, v9, v216
    v_mfma_f32_32x32x16_bf16 v[80:95], a[244:247], v[128:131], v[80:95]
    ds_read_b64_tr_b16 v[158:159], v209 offset:62720
    v_add_f32 v10, v10, v216
    v_add_f32 v11, v11, v216
    v_add_f32 v12, v12, v216
    v_add_f32 v13, v13, v216
    v_add_f32 v14, v14, v216
    v_add_f32 v15, v15, v216
    s_waitcnt lgkmcnt(12)
    v_mfma_f32_32x32x16_bf16 v[16:31], a[248:251], v[132:135], v[16:31]
    ds_read_b64_tr_b16 v[160:161], v209 offset:25088
    buffer_load_dwordx4 v253, s[28:31], s47 offen offset:3072  lds
    v_cvt_pk_bf16_f32 v172, v8, v9
    v_cvt_pk_bf16_f32 v173, v10, v11
    v_cvt_pk_bf16_f32 v174, v12, v13
    v_cvt_pk_bf16_f32 v175, v14, v15
    v_mfma_f32_32x32x16_bf16 v[80:95], a[252:255], v[132:135], v[80:95]
    ds_read_b64_tr_b16 v[162:163], v209 offset:26112
    buffer_store_dwordx4 v[172:175], v201, s[12:15], s43 offen offset:1024 sc1
    v_add_f32 v64, v64, v216
    v_add_f32 v65, v65, v216
    v_add_f32 v66, v66, v216
    v_add_f32 v67, v67, v216
    s_waitcnt lgkmcnt(12)
    v_mfma_f32_32x32x16_bf16 v[16:31], v[184:187], v[136:139], v[16:31]
    ds_read_b64_tr_b16 v[164:165], v209 offset:29184
    v_add_f32 v68, v68, v216
    v_add_f32 v69, v69, v216
    v_add_f32 v70, v70, v216
    v_add_f32 v71, v71, v216
    v_cvt_pk_bf16_f32 v176, v64, v65
    v_cvt_pk_bf16_f32 v177, v66, v67
    v_cvt_pk_bf16_f32 v178, v68, v69
    v_mfma_f32_32x32x16_bf16 v[80:95], v[188:191], v[136:139], v[80:95]
    ds_read_b64_tr_b16 v[166:167], v209 offset:30208
    v_cvt_pk_bf16_f32 v179, v70, v71
    buffer_store_dwordx4 v[176:179], v201, s[12:15], s43 offen offset:2048 sc1
    v_add_f32 v72, v72, v216
    v_add_f32 v73, v73, v216
    v_add_f32 v74, v74, v216
    s_waitcnt lgkmcnt(12)
    v_mfma_f32_32x32x16_bf16 v[16:31], v[192:195], v[140:143], v[16:31]
    ds_read_b64_tr_b16 v[128:129], v209 offset:33280
    v_add_f32 v75, v75, v216
    v_add_f32 v76, v76, v216
    v_add_f32 v77, v77, v216
    v_add_f32 v78, v78, v216
    v_add_f32 v79, v79, v216
    v_cvt_pk_bf16_f32 v180, v72, v73
    v_cvt_pk_bf16_f32 v181, v74, v75
    v_mfma_f32_32x32x16_bf16 v[80:95], v[196:199], v[140:143], v[80:95]
    ds_read_b64_tr_b16 v[130:131], v209 offset:34304
    v_cvt_pk_bf16_f32 v182, v76, v77
    v_cvt_pk_bf16_f32 v183, v78, v79
    buffer_store_dwordx4 v[180:183], v201, s[12:15], s43 offen offset:3072 sc1
    s_waitcnt lgkmcnt(12)
    v_mfma_f32_32x32x16_bf16 v[16:31], a[160:163], v[144:147], v[16:31]
    ds_read_b64_tr_b16 v[132:133], v209 offset:37376
    v_mfma_f32_32x32x16_bf16 v[80:95], a[164:167], v[144:147], v[80:95]
    ds_read_b64_tr_b16 v[134:135], v209 offset:38400
    s_waitcnt lgkmcnt(12)
    v_mfma_f32_32x32x16_bf16 v[16:31], a[168:171], v[148:151], v[16:31]
    ds_read_b64_tr_b16 v[136:137], v209 offset:41472
    v_mfma_f32_32x32x16_bf16 v[80:95], a[172:175], v[148:151], v[80:95]
    ds_read_b64_tr_b16 v[138:139], v209 offset:42496
    s_waitcnt lgkmcnt(12)
    v_mfma_f32_32x32x16_bf16 v[16:31], a[176:179], v[152:155], v[16:31]
    ds_read_b64_tr_b16 v[140:141], v209 offset:45568
    v_mfma_f32_32x32x16_bf16 v[80:95], a[180:183], v[152:155], v[80:95]
    ds_read_b64_tr_b16 v[142:143], v209 offset:46592
    s_waitcnt lgkmcnt(12)
    v_mfma_f32_32x32x16_bf16 v[16:31], a[184:187], v[156:159], v[16:31]
    ds_read_b64_tr_b16 v[144:145], v209 offset:49664
    v_mfma_f32_32x32x16_bf16 v[80:95], a[188:191], v[156:159], v[80:95]
    ds_read_b64_tr_b16 v[146:147], v209 offset:50688
    s_waitcnt lgkmcnt(12)
    v_mfma_f32_32x32x16_bf16 v[32:47], a[224:227], v[160:163], v[32:47]
    ds_read_b64_tr_b16 v[148:149], v209 offset:53760
    v_mfma_f32_32x32x16_bf16 v[96:111], a[228:231], v[160:163], v[96:111]
    ds_read_b64_tr_b16 v[150:151], v209 offset:54784
    s_waitcnt lgkmcnt(12)
    v_mfma_f32_32x32x16_bf16 v[32:47], a[232:235], v[164:167], v[32:47]
    ds_read_b64_tr_b16 v[152:153], v209 offset:57856
    s_nop 0
    v_add_f32 v16, v16, v217
    v_add_f32 v17, v17, v217
    v_add_f32 v18, v18, v217
    v_add_f32 v19, v19, v217
    v_add_f32 v20, v20, v217
    v_add_f32 v21, v21, v217
    v_add_f32 v22, v22, v217
    v_mfma_f32_32x32x16_bf16 v[96:111], a[236:239], v[164:167], v[96:111]
    ds_read_b64_tr_b16 v[154:155], v209 offset:58880
    v_add_f32 v23, v23, v217
    v_cvt_pk_bf16_f32 v168, v16, v17
    v_cvt_pk_bf16_f32 v169, v18, v19
    v_cvt_pk_bf16_f32 v170, v20, v21
    v_cvt_pk_bf16_f32 v171, v22, v23
    s_waitcnt lgkmcnt(12)
    v_mfma_f32_32x32x16_bf16 v[32:47], a[240:243], v[128:131], v[32:47]
    ds_read_b64_tr_b16 v[156:157], v209 offset:61952
    buffer_store_dwordx4 v[168:171], v201, s[12:15], s44 offen offset:0 sc1
    v_add_f32 v24, v24, v217
    v_add_f32 v25, v25, v217
    v_add_f32 v26, v26, v217
    v_add_f32 v27, v27, v217
    v_add_f32 v28, v28, v217
    v_mfma_f32_32x32x16_bf16 v[96:111], a[244:247], v[128:131], v[96:111]
    ds_read_b64_tr_b16 v[158:159], v209 offset:62976
    v_add_f32 v29, v29, v217
    v_add_f32 v30, v30, v217
    v_add_f32 v31, v31, v217
    v_cvt_pk_bf16_f32 v172, v24, v25
    v_cvt_pk_bf16_f32 v173, v26, v27
    v_cvt_pk_bf16_f32 v174, v28, v29
    s_waitcnt lgkmcnt(12)
    v_mfma_f32_32x32x16_bf16 v[32:47], a[248:251], v[132:135], v[32:47]
    ds_read_b64_tr_b16 v[160:161], v209 offset:25344
    v_cvt_pk_bf16_f32 v175, v30, v31
    buffer_store_dwordx4 v[172:175], v201, s[12:15], s44 offen offset:1024 sc1
    v_add_f32 v80, v80, v217
    v_add_f32 v81, v81, v217
    v_add_f32 v82, v82, v217
    v_add_f32 v83, v83, v217
    v_mfma_f32_32x32x16_bf16 v[96:111], a[252:255], v[132:135], v[96:111]
    ds_read_b64_tr_b16 v[162:163], v209 offset:26368
    v_add_f32 v84, v84, v217
    v_add_f32 v85, v85, v217
    v_add_f32 v86, v86, v217
    v_add_f32 v87, v87, v217
    v_cvt_pk_bf16_f32 v176, v80, v81
    v_cvt_pk_bf16_f32 v177, v82, v83
    s_waitcnt lgkmcnt(12)
    v_mfma_f32_32x32x16_bf16 v[32:47], v[184:187], v[136:139], v[32:47]
    ds_read_b64_tr_b16 v[164:165], v209 offset:29440
    v_cvt_pk_bf16_f32 v178, v84, v85
    v_cvt_pk_bf16_f32 v179, v86, v87
    buffer_store_dwordx4 v[176:179], v201, s[12:15], s44 offen offset:2048 sc1
    v_add_f32 v88, v88, v217
    v_add_f32 v89, v89, v217
    v_add_f32 v90, v90, v217
    v_mfma_f32_32x32x16_bf16 v[96:111], v[188:191], v[136:139], v[96:111]
    ds_read_b64_tr_b16 v[166:167], v209 offset:30464
    v_add_f32 v91, v91, v217
    v_add_f32 v92, v92, v217
    v_add_f32 v93, v93, v217
    v_add_f32 v94, v94, v217
    v_add_f32 v95, v95, v217
    v_cvt_pk_bf16_f32 v180, v88, v89
    s_waitcnt lgkmcnt(12)
    v_mfma_f32_32x32x16_bf16 v[32:47], v[192:195], v[140:143], v[32:47]
    ds_read_b64_tr_b16 v[128:129], v209 offset:33536
    v_cvt_pk_bf16_f32 v181, v90, v91
    v_cvt_pk_bf16_f32 v182, v92, v93
    v_cvt_pk_bf16_f32 v183, v94, v95
    buffer_store_dwordx4 v[180:183], v201, s[12:15], s44 offen offset:3072 sc1
    v_mfma_f32_32x32x16_bf16 v[96:111], v[196:199], v[140:143], v[96:111]
    ds_read_b64_tr_b16 v[130:131], v209 offset:34560
    s_waitcnt lgkmcnt(12)
    v_mfma_f32_32x32x16_bf16 v[32:47], a[160:163], v[144:147], v[32:47]
    ds_read_b64_tr_b16 v[132:133], v209 offset:37632
    v_mfma_f32_32x32x16_bf16 v[96:111], a[164:167], v[144:147], v[96:111]
    ds_read_b64_tr_b16 v[134:135], v209 offset:38656
    s_waitcnt lgkmcnt(12)
    v_mfma_f32_32x32x16_bf16 v[32:47], a[168:171], v[148:151], v[32:47]
    ds_read_b64_tr_b16 v[136:137], v209 offset:41728
    v_mfma_f32_32x32x16_bf16 v[96:111], a[172:175], v[148:151], v[96:111]
    ds_read_b64_tr_b16 v[138:139], v209 offset:42752
    s_waitcnt lgkmcnt(12)
    v_mfma_f32_32x32x16_bf16 v[32:47], a[176:179], v[152:155], v[32:47]
    ds_read_b64_tr_b16 v[140:141], v209 offset:45824
    v_mfma_f32_32x32x16_bf16 v[96:111], a[180:183], v[152:155], v[96:111]
    ds_read_b64_tr_b16 v[142:143], v209 offset:46848
    s_waitcnt lgkmcnt(12)
    v_mfma_f32_32x32x16_bf16 v[32:47], a[184:187], v[156:159], v[32:47]
    ds_read_b64_tr_b16 v[144:145], v209 offset:49920
    v_mfma_f32_32x32x16_bf16 v[96:111], a[188:191], v[156:159], v[96:111]
    ds_read_b64_tr_b16 v[146:147], v209 offset:50944
    s_waitcnt lgkmcnt(12)
    v_mfma_f32_32x32x16_bf16 v[48:63], a[224:227], v[160:163], v[48:63]
    ds_read_b64_tr_b16 v[148:149], v209 offset:54016
    v_mfma_f32_32x32x16_bf16 v[112:127], a[228:231], v[160:163], v[112:127]
    ds_read_b64_tr_b16 v[150:151], v209 offset:55040
    s_waitcnt lgkmcnt(12)
    v_mfma_f32_32x32x16_bf16 v[48:63], a[232:235], v[164:167], v[48:63]
    ds_read_b64_tr_b16 v[152:153], v209 offset:58112
    s_nop 0
    v_add_f32 v32, v32, v218
    v_add_f32 v33, v33, v218
    v_add_f32 v34, v34, v218
    v_add_f32 v35, v35, v218
    v_add_f32 v36, v36, v218
    v_add_f32 v37, v37, v218
    v_add_f32 v38, v38, v218
    v_mfma_f32_32x32x16_bf16 v[112:127], a[236:239], v[164:167], v[112:127]
    ds_read_b64_tr_b16 v[154:155], v209 offset:59136
    v_add_f32 v39, v39, v218
    v_cvt_pk_bf16_f32 v168, v32, v33
    v_cvt_pk_bf16_f32 v169, v34, v35
    v_cvt_pk_bf16_f32 v170, v36, v37
    v_cvt_pk_bf16_f32 v171, v38, v39
    s_waitcnt lgkmcnt(12)
    v_mfma_f32_32x32x16_bf16 v[48:63], a[240:243], v[128:131], v[48:63]
    ds_read_b64_tr_b16 v[156:157], v209 offset:62208
    buffer_store_dwordx4 v[168:171], v201, s[12:15], s45 offen offset:0 sc1
    v_add_f32 v40, v40, v218
    v_add_f32 v41, v41, v218
    v_add_f32 v42, v42, v218
    v_add_f32 v43, v43, v218
    v_add_f32 v44, v44, v218
    v_mfma_f32_32x32x16_bf16 v[112:127], a[244:247], v[128:131], v[112:127]
    ds_read_b64_tr_b16 v[158:159], v209 offset:63232
    v_add_f32 v45, v45, v218
    v_add_f32 v46, v46, v218
    v_add_f32 v47, v47, v218
    v_cvt_pk_bf16_f32 v172, v40, v41
    v_cvt_pk_bf16_f32 v173, v42, v43
    v_cvt_pk_bf16_f32 v174, v44, v45
    s_waitcnt lgkmcnt(12)
    v_mfma_f32_32x32x16_bf16 v[48:63], a[248:251], v[132:135], v[48:63]
    v_cvt_pk_bf16_f32 v175, v46, v47
    buffer_store_dwordx4 v[172:175], v201, s[12:15], s45 offen offset:1024 sc1
    v_add_f32 v96, v96, v218
    v_add_f32 v97, v97, v218
    v_add_f32 v98, v98, v218
    v_add_f32 v99, v99, v218
    v_add_f32 v100, v100, v218
    v_mfma_f32_32x32x16_bf16 v[112:127], a[252:255], v[132:135], v[112:127]
    v_add_f32 v101, v101, v218
    v_add_f32 v102, v102, v218
    v_add_f32 v103, v103, v218
    v_cvt_pk_bf16_f32 v176, v96, v97
    v_cvt_pk_bf16_f32 v177, v98, v99
    v_cvt_pk_bf16_f32 v178, v100, v101
    v_cvt_pk_bf16_f32 v179, v102, v103
    s_waitcnt lgkmcnt(10)
    v_mfma_f32_32x32x16_bf16 v[48:63], v[184:187], v[136:139], v[48:63]
    buffer_store_dwordx4 v[176:179], v201, s[12:15], s45 offen offset:2048 sc1
    v_add_f32 v104, v104, v218
    v_add_f32 v105, v105, v218
    v_add_f32 v106, v106, v218
    v_add_f32 v107, v107, v218
    v_add_f32 v108, v108, v218
    v_add_f32 v109, v109, v218
    v_mfma_f32_32x32x16_bf16 v[112:127], v[188:191], v[136:139], v[112:127]
    v_add_f32 v110, v110, v218
    v_add_f32 v111, v111, v218
    v_cvt_pk_bf16_f32 v180, v104, v105
    v_cvt_pk_bf16_f32 v181, v106, v107
    v_cvt_pk_bf16_f32 v182, v108, v109
    v_cvt_pk_bf16_f32 v183, v110, v111
    s_waitcnt lgkmcnt(8)
    v_mfma_f32_32x32x16_bf16 v[48:63], v[192:195], v[140:143], v[48:63]
    buffer_store_dwordx4 v[180:183], v201, s[12:15], s45 offen offset:3072 sc1
    v_mfma_f32_32x32x16_bf16 v[112:127], v[196:199], v[140:143], v[112:127]
    s_waitcnt lgkmcnt(6)
    v_mfma_f32_32x32x16_bf16 v[48:63], a[160:163], v[144:147], v[48:63]
    v_mfma_f32_32x32x16_bf16 v[112:127], a[164:167], v[144:147], v[112:127]
    s_waitcnt lgkmcnt(4)
    v_mfma_f32_32x32x16_bf16 v[48:63], a[168:171], v[148:151], v[48:63]
    v_mfma_f32_32x32x16_bf16 v[112:127], a[172:175], v[148:151], v[112:127]
    s_waitcnt lgkmcnt(2)
    v_mfma_f32_32x32x16_bf16 v[48:63], a[176:179], v[152:155], v[48:63]
    v_mfma_f32_32x32x16_bf16 v[112:127], a[180:183], v[152:155], v[112:127]
    s_waitcnt lgkmcnt(0)
    v_mfma_f32_32x32x16_bf16 v[48:63], a[184:187], v[156:159], v[48:63]
    v_mfma_f32_32x32x16_bf16 v[112:127], a[188:191], v[156:159], v[112:127]
    s_nop 10
    v_add_f32 v48, v48, v219
    v_add_f32 v49, v49, v219
    v_add_f32 v50, v50, v219
    v_add_f32 v51, v51, v219
    v_add_f32 v52, v52, v219
    v_add_f32 v53, v53, v219
    v_add_f32 v54, v54, v219
    v_add_f32 v55, v55, v219
    v_cvt_pk_bf16_f32 v168, v48, v49
    v_cvt_pk_bf16_f32 v169, v50, v51
    v_cvt_pk_bf16_f32 v170, v52, v53
    v_cvt_pk_bf16_f32 v171, v54, v55
    buffer_store_dwordx4 v[168:171], v201, s[12:15], s46 offen offset:0 sc1
    v_add_f32 v56, v56, v219
    v_add_f32 v57, v57, v219
    v_add_f32 v58, v58, v219
    v_add_f32 v59, v59, v219
    v_add_f32 v60, v60, v219
    v_add_f32 v61, v61, v219
    v_add_f32 v62, v62, v219
    v_add_f32 v63, v63, v219
    v_cvt_pk_bf16_f32 v172, v56, v57
    v_cvt_pk_bf16_f32 v173, v58, v59
    v_cvt_pk_bf16_f32 v174, v60, v61
    v_cvt_pk_bf16_f32 v175, v62, v63
    buffer_store_dwordx4 v[172:175], v201, s[12:15], s46 offen offset:1024 sc1
    v_add_f32 v112, v112, v219
    v_add_f32 v113, v113, v219
    v_add_f32 v114, v114, v219
    v_add_f32 v115, v115, v219
    v_add_f32 v116, v116, v219
    v_add_f32 v117, v117, v219
    v_add_f32 v118, v118, v219
    v_add_f32 v119, v119, v219
    v_cvt_pk_bf16_f32 v176, v112, v113
    v_cvt_pk_bf16_f32 v177, v114, v115
    v_cvt_pk_bf16_f32 v178, v116, v117
    v_cvt_pk_bf16_f32 v179, v118, v119
    buffer_store_dwordx4 v[176:179], v201, s[12:15], s46 offen offset:2048 sc1
    v_add_f32 v120, v120, v219
    v_add_f32 v121, v121, v219
    v_add_f32 v122, v122, v219
    v_add_f32 v123, v123, v219
    v_add_f32 v124, v124, v219
    v_add_f32 v125, v125, v219
    v_add_f32 v126, v126, v219
    v_add_f32 v127, v127, v219
    v_cvt_pk_bf16_f32 v180, v120, v121
    v_cvt_pk_bf16_f32 v181, v122, v123
    v_cvt_pk_bf16_f32 v182, v124, v125
    v_cvt_pk_bf16_f32 v183, v126, v127
    buffer_store_dwordx4 v[180:183], v201, s[12:15], s46 offen offset:3072 sc1
    s_waitcnt vmcnt(4)
p_sync3:
    ds_read_b64_tr_b16 a[128:129], v249 offset:0
    ds_read_b64_tr_b16 a[130:131], v249 offset:512
    ds_read_b64_tr_b16 a[132:133], v249 offset:256
    ds_read_b64_tr_b16 a[134:135], v249 offset:768
    ds_read_b64_tr_b16 a[136:137], v249 offset:2048
    ds_read_b64_tr_b16 a[138:139], v249 offset:2560
    ds_read_b64_tr_b16 a[140:141], v249 offset:2304
    ds_read_b64_tr_b16 a[142:143], v249 offset:2816
    ds_read_b64_tr_b16 a[144:145], v249 offset:4096
    ds_read_b64_tr_b16 a[146:147], v249 offset:4608
    ds_read_b64_tr_b16 a[148:149], v249 offset:4352
    ds_read_b64_tr_b16 a[150:151], v249 offset:4864
    ds_read_b64_tr_b16 a[152:153], v249 offset:6144
    ds_read_b64_tr_b16 a[154:155], v249 offset:6656
    ds_read_b64_tr_b16 a[156:157], v249 offset:6400
    ds_read_b64_tr_b16 a[158:159], v249 offset:6912
    ds_read_b64_tr_b16 a[160:161], v249 offset:8192
    ds_read_b64_tr_b16 a[162:163], v249 offset:8704
    ds_read_b64_tr_b16 a[164:165], v249 offset:8448
    ds_read_b64_tr_b16 a[166:167], v249 offset:8960
    ds_read_b64_tr_b16 a[168:169], v249 offset:10240
    ds_read_b64_tr_b16 a[170:171], v249 offset:10752
    ds_read_b64_tr_b16 a[172:173], v249 offset:10496
    ds_read_b64_tr_b16 a[174:175], v249 offset:11008
    ds_read_b64_tr_b16 a[176:177], v249 offset:12288
    ds_read_b64_tr_b16 a[178:179], v249 offset:12800
    ds_read_b64_tr_b16 a[180:181], v249 offset:12544
    ds_read_b64_tr_b16 a[182:183], v249 offset:13056
    ds_read_b64_tr_b16 a[184:185], v249 offset:14336
    ds_read_b64_tr_b16 a[186:187], v249 offset:14848
    ds_read_b64_tr_b16 a[188:189], v249 offset:14592
    ds_read_b64_tr_b16 a[190:191], v249 offset:15104
    ds_read_b64_tr_b16 a[192:193], v249 offset:16384
    ds_read_b64_tr_b16 a[194:195], v249 offset:16896
    ds_read_b64_tr_b16 a[196:197], v249 offset:16640
    ds_read_b64_tr_b16 a[198:199], v249 offset:17152
    ds_read_b64_tr_b16 a[200:201], v249 offset:18432
    ds_read_b64_tr_b16 a[202:203], v249 offset:18944
    ds_read_b64_tr_b16 a[204:205], v249 offset:18688
    ds_read_b64_tr_b16 a[206:207], v249 offset:19200
    ds_read_b64_tr_b16 a[208:209], v254 offset:0
    ds_read_b64_tr_b16 a[210:211], v254 offset:512
    ds_read_b64_tr_b16 a[212:213], v254 offset:256
    ds_read_b64_tr_b16 a[214:215], v254 offset:768
    ds_read_b64_tr_b16 a[216:217], v254 offset:2048
    ds_read_b64_tr_b16 a[218:219], v254 offset:2560
    ds_read_b64_tr_b16 a[220:221], v254 offset:2304
    ds_read_b64_tr_b16 a[222:223], v254 offset:2816
    v_and_b32 v202, 31, v200
    v_lshlrev_b32 v202, 4, v202
    v_lshrrev_b32 v203, 5, v200
    v_mul_u32_u24 v203, 544, v203
    v_add_u32 v202, v202, v203
    s_mul_i32 s43, s3, 16896
    s_add_u32 s43, s43, 81920
    s_and_b32 s45, s3, 1
    s_xor_b32 s44, s45, 0
    s_mul_i32 s44, s44, 4224
    s_add_u32 s44, s44, s43
    v_add_u32 v204, s44, v202
    s_xor_b32 s44, s45, 1
    s_mul_i32 s44, s44, 4224
    s_add_u32 s44, s44, s43
    v_add_u32 v205, s44, v202
    v_lshrrev_b32 v202, 3, v200
    v_lshl_add_u32 v202, s3, 3, v202
    v_lshlrev_b32 v208, 4, v202
    v_lshlrev_b32 v209, 10, v202
    v_and_b32 v203, 7, v200
    v_lshl_add_u32 v209, v203, 4, v209
    v_bfe_u32 v203, v200, 2, 1
    v_mul_u32_u24 v202, 4224, v203
    v_add_u32 v208, v208, v202
    v_bfe_u32 v203, v200, 1, 1
    v_mul_u32_u24 v202, 544, v203
    v_add_u32 v208, v208, v202
    v_and_b32 v203, 1, v200
    v_mul_u32_u24 v202, 2112, v203
    v_add_u32 v208, v208, v202
    v_add_u32 v208, 81920, v208
    s_lshl_b32 s16, s6, 15
    s_lshl_b32 s17, s7, 7
    s_add_u32 s17, s16, s17
    s_add_u32 s18, s17, 65536
    v_and_b32 v241, 0xf00, v233
    s_waitcnt vmcnt(0) lgkmcnt(0)
    s_barrier
    s_cmp_lg_u32 s3, 0
    s_cbranch_scc1 p_w3
    buffer_store_dword v239, v240, s[12:15], s96 offen sc1
    s_mov_b32 s58, 0
    s_mov_b32 exec_lo, 0xffff
    s_mov_b32 exec_hi, 0x0
p_poll3:
    buffer_load_dword v234, v233, s[12:15], s98 offen sc1
    s_add_u32 s58, s58, 1
    s_cmp_ge_u32 s58, 32768
    s_cbranch_scc1 p_poll3_out
    s_waitcnt vmcnt(0)
    v_cmp_gt_u32 vcc, 1, v234
    s_nop 4
    s_cbranch_vccnz p_poll3
p_poll3_out:
    s_waitcnt vmcnt(0)
    s_mov_b64 exec, -1
p_w3:
    s_barrier
    buffer_load_dwordx4 v[64:67], v237, s[12:15], s48 offen offset:0 sc1
    buffer_load_dwordx4 v[68:71], v237, s[12:15], s48 offen offset:1024 sc1
    buffer_load_dwordx4 v[72:75], v237, s[12:15], s48 offen offset:2048 sc1
    buffer_load_dwordx4 v[76:79], v237, s[12:15], s48 offen offset:3072 sc1
    buffer_load_dwordx4 v[80:83], v237, s[12:15], s49 offen offset:0 sc1
    buffer_load_dwordx4 v[84:87], v237, s[12:15], s49 offen offset:1024 sc1
    s_waitcnt vmcnt(5)
    v_mfma_f32_32x32x16_bf16 v[0:15], a[0:3], v[64:67], 0
    buffer_load_dwordx4 v[88:91], v237, s[12:15], s49 offen offset:2048 sc1
    v_mfma_f32_32x32x16_bf16 v[16:31], a[4:7], v[64:67], 0
    buffer_load_dwordx4 v[92:95], v237, s[12:15], s49 offen offset:3072 sc1
    s_waitcnt vmcnt(6)
    v_mfma_f32_32x32x16_bf16 v[0:15], a[8:11], v[68:71], v[0:15]
    buffer_load_dwordx4 v[96:99], v237, s[12:15], s50 offen offset:0 sc1
    v_mfma_f32_32x32x16_bf16 v[16:31], a[12:15], v[68:71], v[16:31]
    buffer_load_dwordx4 v[100:103], v237, s[12:15], s50 offen offset:1024 sc1
    s_waitcnt vmcnt(7)
    v_mfma_f32_32x32x16_bf16 v[0:15], a[16:19], v[72:75], v[0:15]
    buffer_load_dwordx4 v[104:107], v237, s[12:15], s50 offen offset:2048 sc1
    v_mfma_f32_32x32x16_bf16 v[16:31], a[20:23], v[72:75], v[16:31]
    buffer_load_dwordx4 v[108:111], v237, s[12:15], s50 offen offset:3072 sc1
    s_waitcnt vmcnt(8)
    v_mfma_f32_32x32x16_bf16 v[0:15], a[24:27], v[76:79], v[0:15]
    buffer_load_dwordx4 v[112:115], v237, s[12:15], s51 offen offset:0 sc1
    v_mfma_f32_32x32x16_bf16 v[16:31], a[28:31], v[76:79], v[16:31]
    buffer_load_dwordx4 v[116:119], v237, s[12:15], s51 offen offset:1024 sc1
    s_waitcnt vmcnt(9)
    v_mfma_f32_32x32x16_bf16 v[0:15], a[32:35], v[80:83], v[0:15]
    buffer_load_dwordx4 v[120:123], v237, s[12:15], s51 offen offset:2048 sc1
    v_mfma_f32_32x32x16_bf16 v[16:31], a[36:39], v[80:83], v[16:31]
    buffer_load_dwordx4 v[124:127], v237, s[12:15], s51 offen offset:3072 sc1
    s_waitcnt vmcnt(10)
    v_mfma_f32_32x32x16_bf16 v[0:15], a[40:43], v[84:87], v[0:15]
    buffer_load_dwordx4 v[128:131], v237, s[12:15], s52 offen offset:0 sc1
    v_mfma_f32_32x32x16_bf16 v[16:31], a[44:47], v[84:87], v[16:31]
    s_waitcnt vmcnt(10)
    v_mfma_f32_32x32x16_bf16 v[0:15], a[48:51], v[88:91], v[0:15]
    buffer_load_dwordx4 v[132:135], v237, s[12:15], s52 offen offset:1024 sc1
    v_mfma_f32_32x32x16_bf16 v[16:31], a[52:55], v[88:91], v[16:31]
    s_waitcnt vmcnt(10)
    v_mfma_f32_32x32x16_bf16 v[0:15], a[56:59], v[92:95], v[0:15]
    buffer_load_dwordx4 v[136:139], v237, s[12:15], s52 offen offset:2048 sc1
    v_mfma_f32_32x32x16_bf16 v[16:31], a[60:63], v[92:95], v[16:31]
    s_waitcnt vmcnt(10)
    v_mfma_f32_32x32x16_bf16 v[0:15], a[64:67], v[96:99], v[0:15]
    buffer_load_dwordx4 v[140:143], v237, s[12:15], s52 offen offset:3072 sc1
    v_mfma_f32_32x32x16_bf16 v[16:31], a[68:71], v[96:99], v[16:31]
    buffer_load_dwordx4 v[184:187], v201, s[12:15], s55 offen sc1
    buffer_load_dwordx4 v[188:191], v201, s[12:15], s55 offen offset:1024 sc1
    buffer_load_dwordx4 v[192:195], v201, s[12:15], s57 offen sc1
    buffer_load_dwordx4 v[196:199], v201, s[12:15], s57 offen offset:1024 sc1
    s_waitcnt vmcnt(14)
    v_mfma_f32_32x32x16_bf16 v[0:15], a[72:75], v[100:103], v[0:15]
    buffer_load_dwordx4 v[144:147], v237, s[12:15], s53 offen offset:0 sc1
    v_mfma_f32_32x32x16_bf16 v[16:31], a[76:79], v[100:103], v[16:31]
    s_waitcnt vmcnt(14)
    v_mfma_f32_32x32x16_bf16 v[0:15], a[80:83], v[104:107], v[0:15]
    buffer_load_dwordx4 v[148:151], v237, s[12:15], s53 offen offset:1024 sc1
    v_mfma_f32_32x32x16_bf16 v[16:31], a[84:87], v[104:107], v[16:31]
    s_waitcnt vmcnt(14)
    v_mfma_f32_32x32x16_bf16 v[0:15], a[88:91], v[108:111], v[0:15]
    buffer_load_dwordx4 v[152:155], v237, s[12:15], s53 offen offset:2048 sc1
    v_mfma_f32_32x32x16_bf16 v[16:31], a[92:95], v[108:111], v[16:31]
    s_waitcnt vmcnt(14)
    v_mfma_f32_32x32x16_bf16 v[0:15], a[96:99], v[112:115], v[0:15]
    buffer_load_dwordx4 v[156:159], v237, s[12:15], s53 offen offset:3072 sc1
    v_mfma_f32_32x32x16_bf16 v[16:31], a[100:103], v[112:115], v[16:31]
    s_waitcnt vmcnt(14)
    v_mfma_f32_32x32x16_bf16 v[0:15], a[104:107], v[116:119], v[0:15]
    buffer_load_dwordx4 v[160:163], v237, s[12:15], s54 offen offset:0 sc1
    v_mfma_f32_32x32x16_bf16 v[16:31], a[108:111], v[116:119], v[16:31]
    s_waitcnt vmcnt(14)
    v_mfma_f32_32x32x16_bf16 v[0:15], a[112:115], v[120:123], v[0:15]
    buffer_load_dwordx4 v[164:167], v237, s[12:15], s54 offen offset:1024 sc1
    v_mfma_f32_32x32x16_bf16 v[16:31], a[116:119], v[120:123], v[16:31]
    s_waitcnt vmcnt(14)
    v_mfma_f32_32x32x16_bf16 v[0:15], a[120:123], v[124:127], v[0:15]
    buffer_load_dwordx4 v[64:67], v237, s[12:15], s54 offen offset:2048 sc1
    v_mfma_f32_32x32x16_bf16 v[16:31], a[124:127], v[124:127], v[16:31]
    s_waitcnt vmcnt(14)
    v_mfma_f32_32x32x16_bf16 v[0:15], a[128:131], v[128:131], v[0:15]
    buffer_load_dwordx4 v[68:71], v237, s[12:15], s54 offen offset:3072 sc1
    v_mfma_f32_32x32x16_bf16 v[16:31], a[132:135], v[128:131], v[16:31]
    s_waitcnt vmcnt(14)
    v_mfma_f32_32x32x16_bf16 v[0:15], a[136:139], v[132:135], v[0:15]
    buffer_load_dwordx4 v[72:75], v238, s[12:15], s48 offen offset:0 sc1
    v_mfma_f32_32x32x16_bf16 v[16:31], a[140:143], v[132:135], v[16:31]
    s_waitcnt vmcnt(14)
    v_mfma_f32_32x32x16_bf16 v[0:15], a[144:147], v[136:139], v[0:15]
    buffer_load_dwordx4 v[76:79], v238, s[12:15], s48 offen offset:1024 sc1
    v_mfma_f32_32x32x16_bf16 v[16:31], a[148:151], v[136:139], v[16:31]
    s_waitcnt vmcnt(14)
    v_mfma_f32_32x32x16_bf16 v[0:15], a[152:155], v[140:143], v[0:15]
    buffer_load_dwordx4 v[80:83], v238, s[12:15], s48 offen offset:2048 sc1
    v_mfma_f32_32x32x16_bf16 v[16:31], a[156:159], v[140:143], v[16:31]
    s_waitcnt vmcnt(10)
    v_mfma_f32_32x32x16_bf16 v[0:15], a[160:163], v[144:147], v[0:15]
    buffer_load_dwordx4 v[84:87], v238, s[12:15], s48 offen offset:3072 sc1
    v_mfma_f32_32x32x16_bf16 v[16:31], a[164:167], v[144:147], v[16:31]
    s_waitcnt vmcnt(10)
    v_mfma_f32_32x32x16_bf16 v[0:15], a[168:171], v[148:151], v[0:15]
    buffer_load_dwordx4 v[88:91], v238, s[12:15], s49 offen offset:0 sc1
    v_mfma_f32_32x32x16_bf16 v[16:31], a[172:175], v[148:151], v[16:31]
    s_waitcnt vmcnt(10)
    v_mfma_f32_32x32x16_bf16 v[0:15], a[176:179], v[152:155], v[0:15]
    buffer_load_dwordx4 v[92:95], v238, s[12:15], s49 offen offset:1024 sc1
    v_lshlrev_b32 v168, 16, v184
    v_and_b32 v169, 0xffff0000, v184
    v_mfma_f32_32x32x16_bf16 v[16:31], a[180:183], v[152:155], v[16:31]
    v_lshlrev_b32 v170, 16, v185
    v_and_b32 v171, 0xffff0000, v185
    s_waitcnt vmcnt(10)
    v_mfma_f32_32x32x16_bf16 v[0:15], a[184:187], v[156:159], v[0:15]
    buffer_load_dwordx4 v[96:99], v238, s[12:15], s49 offen offset:2048 sc1
    v_lshlrev_b32 v172, 16, v186
    v_and_b32 v173, 0xffff0000, v186
    v_mfma_f32_32x32x16_bf16 v[16:31], a[188:191], v[156:159], v[16:31]
    v_lshlrev_b32 v174, 16, v187
    v_and_b32 v175, 0xffff0000, v187
    s_waitcnt vmcnt(10)
    v_mfma_f32_32x32x16_bf16 v[0:15], a[192:195], v[160:163], v[0:15]
    buffer_load_dwordx4 v[100:103], v238, s[12:15], s49 offen offset:3072 sc1
    v_lshlrev_b32 v176, 16, v188
    v_and_b32 v177, 0xffff0000, v188
    v_mfma_f32_32x32x16_bf16 v[16:31], a[196:199], v[160:163], v[16:31]
    v_lshlrev_b32 v178, 16, v189
    v_and_b32 v179, 0xffff0000, v189
    s_waitcnt vmcnt(10)
    v_mfma_f32_32x32x16_bf16 v[0:15], a[200:203], v[164:167], v[0:15]
    buffer_load_dwordx4 v[104:107], v238, s[12:15], s50 offen offset:0 sc1
    v_lshlrev_b32 v180, 16, v190
    v_and_b32 v181, 0xffff0000, v190
    v_mfma_f32_32x32x16_bf16 v[16:31], a[204:207], v[164:167], v[16:31]
    v_lshlrev_b32 v182, 16, v191
    v_and_b32 v183, 0xffff0000, v191
    s_waitcnt vmcnt(10)
    v_mfma_f32_32x32x16_bf16 v[0:15], a[208:211], v[64:67], v[0:15]
    buffer_load_dwordx4 v[108:111], v238, s[12:15], s50 offen offset:1024 sc1
    v_lshlrev_b32 v32, 16, v192
    v_and_b32 v33, 0xffff0000, v192
    v_lshlrev_b32 v34, 16, v193
    v_and_b32 v35, 0xffff0000, v193
    v_mfma_f32_32x32x16_bf16 v[16:31], a[212:215], v[64:67], v[16:31]
    v_lshlrev_b32 v36, 16, v194
    v_and_b32 v37, 0xffff0000, v194
    v_lshlrev_b32 v38, 16, v195
    v_and_b32 v39, 0xffff0000, v195
    s_waitcnt vmcnt(10)
    v_mfma_f32_32x32x16_bf16 v[0:15], a[216:219], v[68:71], v[0:15]
    buffer_load_dwordx4 v[112:115], v238, s[12:15], s50 offen offset:2048 sc1
    v_lshlrev_b32 v40, 16, v196
    v_and_b32 v41, 0xffff0000, v196
    v_lshlrev_b32 v42, 16, v197
    v_and_b32 v43, 0xffff0000, v197
    v_mfma_f32_32x32x16_bf16 v[16:31], a[220:223], v[68:71], v[16:31]
    v_lshlrev_b32 v44, 16, v198
    v_and_b32 v45, 0xffff0000, v198
    v_lshlrev_b32 v46, 16, v199
    v_and_b32 v47, 0xffff0000, v199
    s_waitcnt vmcnt(10)
    s_nop 0
    v_mfma_f32_32x32x16_bf16 v[32:47], a[0:3], v[72:75], v[32:47]
    buffer_load_dwordx4 v[116:119], v238, s[12:15], s50 offen offset:3072 sc1
    v_mfma_f32_32x32x16_bf16 v[48:63], a[4:7], v[72:75], 0
    s_waitcnt vmcnt(10)
    v_mfma_f32_32x32x16_bf16 v[32:47], a[8:11], v[76:79], v[32:47]
    buffer_load_dwordx4 v[120:123], v238, s[12:15], s51 offen offset:0 sc1
    v_mfma_f32_32x32x16_bf16 v[48:63], a[12:15], v[76:79], v[48:63]
    s_waitcnt vmcnt(10)
    v_mfma_f32_32x32x16_bf16 v[32:47], a[16:19], v[80:83], v[32:47]
    buffer_load_dwordx4 v[124:127], v238, s[12:15], s51 offen offset:1024 sc1
    ds_write_b128 v205, v[16:19] offset:0
    v_mfma_f32_32x32x16_bf16 v[48:63], a[20:23], v[80:83], v[48:63]
    v_add_f32 v0, v0, v168
    v_add_f32 v1, v1, v169
    v_add_f32 v2, v2, v170
    v_add_f32 v3, v3, v171
    s_waitcnt vmcnt(10)
    v_mfma_f32_32x32x16_bf16 v[32:47], a[24:27], v[84:87], v[32:47]
    buffer_load_dwordx4 v[128:131], v238, s[12:15], s51 offen offset:2048 sc1
    ds_write_b128 v205, v[20:23] offset:1056
    v_mfma_f32_32x32x16_bf16 v[48:63], a[28:31], v[84:87], v[48:63]
    v_add_f32 v4, v4, v172
    v_add_f32 v5, v5, v173
    v_add_f32 v6, v6, v174
    v_add_f32 v7, v7, v175
    s_waitcnt vmcnt(10)
    v_mfma_f32_32x32x16_bf16 v[32:47], a[32:35], v[88:91], v[32:47]
    buffer_load_dwordx4 v[132:135], v238, s[12:15], s51 offen offset:3072 sc1
    ds_write_b128 v205, v[24:27] offset:2112
    v_mfma_f32_32x32x16_bf16 v[48:63], a[36:39], v[88:91], v[48:63]
    v_add_f32 v8, v8, v176
    v_add_f32 v9, v9, v177
    v_add_f32 v10, v10, v178
    v_add_f32 v11, v11, v179
    s_waitcnt vmcnt(10)
    v_mfma_f32_32x32x16_bf16 v[32:47], a[40:43], v[92:95], v[32:47]
    buffer_load_dwordx4 v[136:139], v238, s[12:15], s52 offen offset:0 sc1
    ds_write_b128 v205, v[28:31] offset:3168
    v_mfma_f32_32x32x16_bf16 v[48:63], a[44:47], v[92:95], v[48:63]
    v_add_f32 v12, v12, v180
    v_add_f32 v13, v13, v181
    v_add_f32 v14, v14, v182
    v_add_f32 v15, v15, v183
    s_waitcnt vmcnt(10)
    v_mfma_f32_32x32x16_bf16 v[32:47], a[48:51], v[96:99], v[32:47]
    buffer_load_dwordx4 v[140:143], v238, s[12:15], s52 offen offset:1024 sc1
    ds_write_b128 v204, v[0:3] offset:0
    v_mfma_f32_32x32x16_bf16 v[48:63], a[52:55], v[96:99], v[48:63]
    s_waitcnt vmcnt(10)
    v_mfma_f32_32x32x16_bf16 v[32:47], a[56:59], v[100:103], v[32:47]
    buffer_load_dwordx4 v[144:147], v238, s[12:15], s52 offen offset:2048 sc1
    ds_write_b128 v204, v[4:7] offset:1056
    v_mfma_f32_32x32x16_bf16 v[48:63], a[60:63], v[100:103], v[48:63]
    s_waitcnt vmcnt(10)
    v_mfma_f32_32x32x16_bf16 v[32:47], a[64:67], v[104:107], v[32:47]
    buffer_load_dwordx4 v[148:151], v238, s[12:15], s52 offen offset:3072 sc1
    ds_write_b128 v204, v[8:11] offset:2112
    v_mfma_f32_32x32x16_bf16 v[48:63], a[68:71], v[104:107], v[48:63]
    s_waitcnt vmcnt(10)
    v_mfma_f32_32x32x16_bf16 v[32:47], a[72:75], v[108:111], v[32:47]
    buffer_load_dwordx4 v[152:155], v238, s[12:15], s53 offen offset:0 sc1
    ds_write_b128 v204, v[12:15] offset:3168
    v_mfma_f32_32x32x16_bf16 v[48:63], a[76:79], v[108:111], v[48:63]
    s_waitcnt vmcnt(10)
    v_mfma_f32_32x32x16_bf16 v[32:47], a[80:83], v[112:115], v[32:47]
    buffer_load_dwordx4 v[156:159], v238, s[12:15], s53 offen offset:1024 sc1
    v_mfma_f32_32x32x16_bf16 v[48:63], a[84:87], v[112:115], v[48:63]
    s_waitcnt vmcnt(10)
    v_mfma_f32_32x32x16_bf16 v[32:47], a[88:91], v[116:119], v[32:47]
    buffer_load_dwordx4 v[160:163], v238, s[12:15], s53 offen offset:2048 sc1
    v_mfma_f32_32x32x16_bf16 v[48:63], a[92:95], v[116:119], v[48:63]
    s_waitcnt lgkmcnt(0)
    s_barrier
    s_waitcnt vmcnt(10)
    v_mfma_f32_32x32x16_bf16 v[32:47], a[96:99], v[120:123], v[32:47]
    buffer_load_dwordx4 v[164:167], v238, s[12:15], s53 offen offset:3072 sc1
    ds_read_b128 v[0:3], v208 offset:0
    v_mfma_f32_32x32x16_bf16 v[48:63], a[100:103], v[120:123], v[48:63]
    ds_read_b128 v[4:7], v208 offset:1056
    s_waitcnt vmcnt(10)
    v_mfma_f32_32x32x16_bf16 v[32:47], a[104:107], v[124:127], v[32:47]
    buffer_load_dwordx4 v[64:67], v238, s[12:15], s54 offen offset:0 sc1
    ds_read_b128 v[8:11], v208 offset:16896
    v_mfma_f32_32x32x16_bf16 v[48:63], a[108:111], v[124:127], v[48:63]
    ds_read_b128 v[12:15], v208 offset:17952
    s_waitcnt vmcnt(10)
    v_mfma_f32_32x32x16_bf16 v[32:47], a[112:115], v[128:131], v[32:47]
    buffer_load_dwordx4 v[68:71], v238, s[12:15], s54 offen offset:1024 sc1
    ds_read_b128 v[16:19], v208 offset:33792
    v_mfma_f32_32x32x16_bf16 v[48:63], a[116:119], v[128:131], v[48:63]
    ds_read_b128 v[20:23], v208 offset:34848
    s_waitcnt vmcnt(10)
    v_mfma_f32_32x32x16_bf16 v[32:47], a[120:123], v[132:135], v[32:47]
    buffer_load_dwordx4 v[72:75], v238, s[12:15], s54 offen offset:2048 sc1
    ds_read_b128 v[24:27], v208 offset:50688
    v_mfma_f32_32x32x16_bf16 v[48:63], a[124:127], v[132:135], v[48:63]
    ds_read_b128 v[28:31], v208 offset:51744
    s_waitcnt vmcnt(10)
    v_mfma_f32_32x32x16_bf16 v[32:47], a[128:131], v[136:139], v[32:47]
    buffer_load_dwordx4 v[76:79], v238, s[12:15], s54 offen offset:3072 sc1
    s_waitcnt lgkmcnt(5)
    v_pk_add_f32 v[0:1], v[0:1], v[8:9]
    v_pk_add_f32 v[2:3], v[2:3], v[10:11]
    v_mfma_f32_32x32x16_bf16 v[48:63], a[132:135], v[136:139], v[48:63]
    s_waitcnt lgkmcnt(4)
    v_pk_add_f32 v[4:5], v[4:5], v[12:13]
    v_pk_add_f32 v[6:7], v[6:7], v[14:15]
    s_waitcnt vmcnt(10)
    v_mfma_f32_32x32x16_bf16 v[32:47], a[136:139], v[140:143], v[32:47]
    s_waitcnt lgkmcnt(3)
    v_pk_add_f32 v[0:1], v[0:1], v[16:17]
    v_pk_add_f32 v[2:3], v[2:3], v[18:19]
    v_mfma_f32_32x32x16_bf16 v[48:63], a[140:143], v[140:143], v[48:63]
    s_waitcnt lgkmcnt(2)
    v_pk_add_f32 v[4:5], v[4:5], v[20:21]
    v_pk_add_f32 v[6:7], v[6:7], v[22:23]
    s_waitcnt vmcnt(9)
    v_mfma_f32_32x32x16_bf16 v[32:47], a[144:147], v[144:147], v[32:47]
    s_waitcnt lgkmcnt(1)
    v_pk_add_f32 v[0:1], v[0:1], v[24:25]
    v_pk_add_f32 v[2:3], v[2:3], v[26:27]
    v_mfma_f32_32x32x16_bf16 v[48:63], a[148:151], v[144:147], v[48:63]
    s_waitcnt lgkmcnt(0)
    v_pk_add_f32 v[4:5], v[4:5], v[28:29]
    v_pk_add_f32 v[6:7], v[6:7], v[30:31]
    s_waitcnt vmcnt(8)
    v_mfma_f32_32x32x16_bf16 v[32:47], a[152:155], v[148:151], v[32:47]
    v_cvt_pk_bf16_f32 v8, v0, v1
    v_cvt_pk_bf16_f32 v9, v2, v3
    v_cvt_pk_bf16_f32 v10, v4, v5
    v_cvt_pk_bf16_f32 v11, v6, v7
    buffer_store_dwordx4 v[8:11], v209, s[36:39], s17 offen nt
    v_mfma_f32_32x32x16_bf16 v[48:63], a[156:159], v[148:151], v[48:63]
    s_waitcnt vmcnt(8)
    v_mfma_f32_32x32x16_bf16 v[32:47], a[160:163], v[152:155], v[32:47]
    v_mfma_f32_32x32x16_bf16 v[48:63], a[164:167], v[152:155], v[48:63]
    s_waitcnt vmcnt(7)
    v_mfma_f32_32x32x16_bf16 v[32:47], a[168:171], v[156:159], v[32:47]
    v_mfma_f32_32x32x16_bf16 v[48:63], a[172:175], v[156:159], v[48:63]
    s_waitcnt vmcnt(6)
    v_mfma_f32_32x32x16_bf16 v[32:47], a[176:179], v[160:163], v[32:47]
    v_mfma_f32_32x32x16_bf16 v[48:63], a[180:183], v[160:163], v[48:63]
    s_waitcnt vmcnt(5)
    v_mfma_f32_32x32x16_bf16 v[32:47], a[184:187], v[164:167], v[32:47]
    v_mfma_f32_32x32x16_bf16 v[48:63], a[188:191], v[164:167], v[48:63]
    s_waitcnt vmcnt(4)
    v_mfma_f32_32x32x16_bf16 v[32:47], a[192:195], v[64:67], v[32:47]
    v_mfma_f32_32x32x16_bf16 v[48:63], a[196:199], v[64:67], v[48:63]
    s_waitcnt vmcnt(3)
    v_mfma_f32_32x32x16_bf16 v[32:47], a[200:203], v[68:71], v[32:47]
    v_mfma_f32_32x32x16_bf16 v[48:63], a[204:207], v[68:71], v[48:63]
    s_waitcnt vmcnt(2)
    v_mfma_f32_32x32x16_bf16 v[32:47], a[208:211], v[72:75], v[32:47]
    v_mfma_f32_32x32x16_bf16 v[48:63], a[212:215], v[72:75], v[48:63]
    s_waitcnt vmcnt(1)
    v_mfma_f32_32x32x16_bf16 v[32:47], a[216:219], v[76:79], v[32:47]
    v_mfma_f32_32x32x16_bf16 v[48:63], a[220:223], v[76:79], v[48:63]
    s_nop 10
    ds_write_b128 v204, v[32:35] offset:8448
    ds_write_b128 v204, v[36:39] offset:9504
    ds_write_b128 v204, v[40:43] offset:10560
    ds_write_b128 v204, v[44:47] offset:11616
    ds_write_b128 v205, v[48:51] offset:8448
    ds_write_b128 v205, v[52:55] offset:9504
    ds_write_b128 v205, v[56:59] offset:10560
    ds_write_b128 v205, v[60:63] offset:11616
    s_waitcnt lgkmcnt(0)
    s_barrier
    ds_read_b128 v[64:67], v208 offset:8448
    ds_read_b128 v[68:71], v208 offset:9504
    ds_read_b128 v[72:75], v208 offset:25344
    ds_read_b128 v[76:79], v208 offset:26400
    ds_read_b128 v[80:83], v208 offset:42240
    ds_read_b128 v[84:87], v208 offset:43296
    ds_read_b128 v[88:91], v208 offset:59136
    ds_read_b128 v[92:95], v208 offset:60192
    s_waitcnt lgkmcnt(5)
    v_pk_add_f32 v[64:65], v[64:65], v[72:73]
    v_pk_add_f32 v[66:67], v[66:67], v[74:75]
    s_waitcnt lgkmcnt(4)
    v_pk_add_f32 v[68:69], v[68:69], v[76:77]
    v_pk_add_f32 v[70:71], v[70:71], v[78:79]
    s_waitcnt lgkmcnt(3)
    v_pk_add_f32 v[64:65], v[64:65], v[80:81]
    v_pk_add_f32 v[66:67], v[66:67], v[82:83]
    s_waitcnt lgkmcnt(2)
    v_pk_add_f32 v[68:69], v[68:69], v[84:85]
    v_pk_add_f32 v[70:71], v[70:71], v[86:87]
    s_waitcnt lgkmcnt(1)
    v_pk_add_f32 v[64:65], v[64:65], v[88:89]
    v_pk_add_f32 v[66:67], v[66:67], v[90:91]
    s_waitcnt lgkmcnt(0)
    v_pk_add_f32 v[68:69], v[68:69], v[92:93]
    v_pk_add_f32 v[70:71], v[70:71], v[94:95]
    v_cvt_pk_bf16_f32 v72, v64, v65
    v_cvt_pk_bf16_f32 v73, v66, v67
    v_cvt_pk_bf16_f32 v74, v68, v69
    v_cvt_pk_bf16_f32 v75, v70, v71
    buffer_store_dwordx4 v[72:75], v209, s[36:39], s18 offen nt
p_done:
    s_endpgm
p_vg0:
    s_add_u32 s19, s19, 1
    s_cmp_ge_u32 s19, 32768
    s_cbranch_scc1 p_wg0
    s_mov_b32 s20, m0
    s_add_u32 m0, s17, 0
    s_add_u32 s21, s16, 0
    buffer_load_dwordx4 v204, s[12:15], s21 offen offset:0 sc1 lds
    buffer_load_dwordx4 v205, s[12:15], s21 offen offset:1024 sc1 lds
    buffer_load_dwordx4 v206, s[12:15], s21 offen offset:2048 sc1 lds
    buffer_load_dwordx4 v207, s[12:15], s21 offen offset:3072 sc1 lds
    s_mov_b32 m0, s20
    s_waitcnt vmcnt(0)
    ds_read2st64_b32 v[220:221], v241 offset0:0 offset1:4
    ds_read2st64_b32 v[222:223], v241 offset0:8 offset1:12
    s_waitcnt lgkmcnt(0)
    v_max3_u32 v220, v220, v221, v222
    v_max_u32 v220, v220, v223
    v_cmp_eq_u32 vcc, -1, v220
    s_nop 4
    s_cbranch_vccnz p_vg0
    s_branch p_wg0
p_vg1:
    s_add_u32 s19, s19, 1
    s_cmp_ge_u32 s19, 32768
    s_cbranch_scc1 p_wg1
    s_mov_b32 s20, m0
    s_add_u32 m0, s17, 16384
    s_add_u32 s21, s16, 278528
    buffer_load_dwordx4 v204, s[12:15], s21 offen offset:0 sc1 lds
    buffer_load_dwordx4 v205, s[12:15], s21 offen offset:1024 sc1 lds
    buffer_load_dwordx4 v206, s[12:15], s21 offen offset:2048 sc1 lds
    buffer_load_dwordx4 v207, s[12:15], s21 offen offset:3072 sc1 lds
    s_mov_b32 m0, s20
    s_waitcnt vmcnt(0)
    ds_read2st64_b32 v[220:221], v241 offset0:64 offset1:68
    ds_read2st64_b32 v[222:223], v241 offset0:72 offset1:76
    s_waitcnt lgkmcnt(0)
    v_max3_u32 v220, v220, v221, v222
    v_max_u32 v220, v220, v223
    v_cmp_eq_u32 vcc, -1, v220
    s_nop 4
    s_cbranch_vccnz p_vg1
    s_branch p_wg1
p_vg2:
    s_add_u32 s19, s19, 1
    s_cmp_ge_u32 s19, 32768
    s_cbranch_scc1 p_wg2
    s_mov_b32 s20, m0
    s_add_u32 m0, s17, 32768
    s_add_u32 s21, s16, 557056
    buffer_load_dwordx4 v204, s[12:15], s21 offen offset:0 sc1 lds
    buffer_load_dwordx4 v205, s[12:15], s21 offen offset:1024 sc1 lds
    buffer_load_dwordx4 v206, s[12:15], s21 offen offset:2048 sc1 lds
    buffer_load_dwordx4 v207, s[12:15], s21 offen offset:3072 sc1 lds
    s_mov_b32 m0, s11
    s_nop 0
    buffer_load_dwordx4 v204, s[12:15], s10 offen offset:0 sc1 lds
    buffer_load_dwordx4 v205, s[12:15], s10 offen offset:1024 sc1 lds
    s_mov_b32 m0, s20
    s_waitcnt vmcnt(0)
    ds_read2st64_b32 v[220:221], v241 offset0:128 offset1:132
    ds_read2st64_b32 v[222:223], v241 offset0:136 offset1:140
    ds_read2st64_b32 v[214:215], v243 offset0:0 offset1:4
    s_waitcnt lgkmcnt(0)
    v_max3_u32 v220, v220, v221, v222
    v_max3_u32 v220, v220, v214, v215
    v_max_u32 v220, v220, v223
    v_cmp_eq_u32 vcc, -1, v220
    s_nop 4
    s_cbranch_vccnz p_vg2
    s_branch p_wg2
p_vg3:
    s_add_u32 s19, s19, 1
    s_cmp_ge_u32 s19, 32768
    s_cbranch_scc1 p_wg3
    s_mov_b32 s20, m0
    s_add_u32 m0, s17, 49152
    s_add_u32 s21, s16, 835584
    buffer_load_dwordx4 v204, s[12:15], s21 offen offset:0 sc1 lds
    buffer_load_dwordx4 v205, s[12:15], s21 offen offset:1024 sc1 lds
    buffer_load_dwordx4 v206, s[12:15], s21 offen offset:2048 sc1 lds
    buffer_load_dwordx4 v207, s[12:15], s21 offen offset:3072 sc1 lds
    s_mov_b32 m0, s20
    s_waitcnt vmcnt(0)
    ds_read2st64_b32 v[220:221], v241 offset0:192 offset1:196
    ds_read2st64_b32 v[222:223], v241 offset0:200 offset1:204
    s_waitcnt lgkmcnt(0)
    v_max3_u32 v220, v220, v221, v222
    v_max_u32 v220, v220, v223
    v_cmp_eq_u32 vcc, -1, v220
    s_nop 4
    s_cbranch_vccnz p_vg3
    s_branch p_wg3
p_vg4:
    s_add_u32 s19, s19, 1
    s_cmp_ge_u32 s19, 32768
    s_cbranch_scc1 p_wg4
    s_mov_b32 s20, m0
    s_add_u32 m0, s17, 65536
    s_add_u32 s21, s16, 1114112
    buffer_load_dwordx4 v204, s[12:15], s21 offen offset:0 sc1 lds
    buffer_load_dwordx4 v205, s[12:15], s21 offen offset:1024 sc1 lds
    buffer_load_dwordx4 v206, s[12:15], s21 offen offset:2048 sc1 lds
    buffer_load_dwordx4 v207, s[12:15], s21 offen offset:3072 sc1 lds
    s_mov_b32 m0, s20
    s_waitcnt vmcnt(0)
    ds_read2st64_b32 v[220:221], v242 offset0:0 offset1:4
    ds_read2st64_b32 v[222:223], v242 offset0:8 offset1:12
    s_waitcnt lgkmcnt(0)
    v_max3_u32 v220, v220, v221, v222
    v_max_u32 v220, v220, v223
    v_cmp_eq_u32 vcc, -1, v220
    s_nop 4
    s_cbranch_vccnz p_vg4
    s_branch p_wg4
p_vg5:
    s_add_u32 s19, s19, 1
    s_cmp_ge_u32 s19, 32768
    s_cbranch_scc1 p_wg5
    s_mov_b32 s20, m0
    s_add_u32 m0, s17, 81920
    s_add_u32 s21, s16, 1392640
    buffer_load_dwordx4 v204, s[12:15], s21 offen offset:0 sc1 lds
    buffer_load_dwordx4 v205, s[12:15], s21 offen offset:1024 sc1 lds
    buffer_load_dwordx4 v206, s[12:15], s21 offen offset:2048 sc1 lds
    buffer_load_dwordx4 v207, s[12:15], s21 offen offset:3072 sc1 lds
    s_mov_b32 m0, s20
    s_waitcnt vmcnt(0)
    ds_read2st64_b32 v[220:221], v242 offset0:64 offset1:68
    ds_read2st64_b32 v[222:223], v242 offset0:72 offset1:76
    s_waitcnt lgkmcnt(0)
    v_max3_u32 v220, v220, v221, v222
    v_max_u32 v220, v220, v223
    v_cmp_eq_u32 vcc, -1, v220
    s_nop 4
    s_cbranch_vccnz p_vg5
    s_branch p_wg5
p_vg6:
    s_add_u32 s19, s19, 1
    s_cmp_ge_u32 s19, 32768
    s_cbranch_scc1 p_wg6
    s_mov_b32 s20, m0
    s_add_u32 m0, s17, 98304
    s_add_u32 s21, s16, 1671168
    buffer_load_dwordx4 v204, s[12:15], s21 offen offset:0 sc1 lds
    buffer_load_dwordx4 v205, s[12:15], s21 offen offset:1024 sc1 lds
    buffer_load_dwordx4 v206, s[12:15], s21 offen offset:2048 sc1 lds
    buffer_load_dwordx4 v207, s[12:15], s21 offen offset:3072 sc1 lds
    s_mov_b32 m0, s20
    s_waitcnt vmcnt(0)
    ds_read2st64_b32 v[220:221], v242 offset0:128 offset1:132
    ds_read2st64_b32 v[222:223], v242 offset0:136 offset1:140
    s_waitcnt lgkmcnt(0)
    v_max3_u32 v220, v220, v221, v222
    v_max_u32 v220, v220, v223
    v_cmp_eq_u32 vcc, -1, v220
    s_nop 4
    s_cbranch_vccnz p_vg6
    s_branch p_wg6
p_vg7:
    s_add_u32 s19, s19, 1
    s_cmp_ge_u32 s19, 32768
    s_cbranch_scc1 p_wg7
    s_mov_b32 s20, m0
    s_add_u32 m0, s17, 114688
    s_add_u32 s21, s16, 1949696
    buffer_load_dwordx4 v204, s[12:15], s21 offen offset:0 sc1 lds
    buffer_load_dwordx4 v205, s[12:15], s21 offen offset:1024 sc1 lds
    buffer_load_dwordx4 v206, s[12:15], s21 offen offset:2048 sc1 lds
    buffer_load_dwordx4 v207, s[12:15], s21 offen offset:3072 sc1 lds
    s_mov_b32 m0, s20
    s_waitcnt vmcnt(0)
    ds_read2st64_b32 v[220:221], v242 offset0:192 offset1:196
    ds_read2st64_b32 v[222:223], v242 offset0:200 offset1:204
    s_waitcnt lgkmcnt(0)
    v_max3_u32 v220, v220, v221, v222
    v_max_u32 v220, v220, v223
    v_cmp_eq_u32 vcc, -1, v220
    s_nop 4
    s_cbranch_vccnz p_vg7
    s_branch p_wg7
p_vh0:
    s_add_u32 s19, s19, 1
    s_cmp_ge_u32 s19, 32768
    s_cbranch_scc1 p_wh0
    s_mov_b32 s20, m0
    s_add_u32 m0, s17, 0
    s_add_u32 s21, s16, 0
    buffer_load_dwordx4 v204, s[12:15], s21 offen offset:0 sc1 lds
    buffer_load_dwordx4 v205, s[12:15], s21 offen offset:1024 sc1 lds
    buffer_load_dwordx4 v206, s[12:15], s21 offen offset:2048 sc1 lds
    buffer_load_dwordx4 v207, s[12:15], s21 offen offset:3072 sc1 lds
    s_mov_b32 m0, s20
    s_waitcnt vmcnt(0)
    ds_read2st64_b32 v[220:221], v241 offset0:0 offset1:4
    ds_read2st64_b32 v[222:223], v241 offset0:8 offset1:12
    s_waitcnt lgkmcnt(0)
    v_max3_u32 v220, v220, v221, v222
    v_max_u32 v220, v220, v223
    v_cmp_eq_u32 vcc, -1, v220
    s_nop 4
    s_cbranch_vccnz p_vh0
    s_branch p_wh0
p_vh1:
    s_add_u32 s19, s19, 1
    s_cmp_ge_u32 s19, 32768
    s_cbranch_scc1 p_wh1
    s_mov_b32 s20, m0
    s_add_u32 m0, s17, 16384
    s_add_u32 s21, s16, 278528
    buffer_load_dwordx4 v204, s[12:15], s21 offen offset:0 sc1 lds
    buffer_load_dwordx4 v205, s[12:15], s21 offen offset:1024 sc1 lds
    buffer_load_dwordx4 v206, s[12:15], s21 offen offset:2048 sc1 lds
    buffer_load_dwordx4 v207, s[12:15], s21 offen offset:3072 sc1 lds
    s_mov_b32 m0, s20
    s_waitcnt vmcnt(0)
    ds_read2st64_b32 v[220:221], v241 offset0:64 offset1:68
    ds_read2st64_b32 v[222:223], v241 offset0:72 offset1:76
    s_waitcnt lgkmcnt(0)
    v_max3_u32 v220, v220, v221, v222
    v_max_u32 v220, v220, v223
    v_cmp_eq_u32 vcc, -1, v220
    s_nop 4
    s_cbranch_vccnz p_vh1
    s_branch p_wh1
p_vh2:
    s_add_u32 s19, s19, 1
    s_cmp_ge_u32 s19, 32768
    s_cbranch_scc1 p_wh2
    s_mov_b32 s20, m0
    s_add_u32 m0, s17, 32768
    s_add_u32 s21, s16, 557056
    buffer_load_dwordx4 v204, s[12:15], s21 offen offset:0 sc1 lds
    buffer_load_dwordx4 v205, s[12:15], s21 offen offset:1024 sc1 lds
    buffer_load_dwordx4 v206, s[12:15], s21 offen offset:2048 sc1 lds
    buffer_load_dwordx4 v207, s[12:15], s21 offen offset:3072 sc1 lds
    s_mov_b32 m0, s11
    s_nop 0
    buffer_load_dwordx4 v204, s[12:15], s10 offen offset:0 sc1 lds
    buffer_load_dwordx4 v205, s[12:15], s10 offen offset:1024 sc1 lds
    s_mov_b32 m0, s20
    s_waitcnt vmcnt(0)
    ds_read2st64_b32 v[220:221], v241 offset0:128 offset1:132
    ds_read2st64_b32 v[222:223], v241 offset0:136 offset1:140
    ds_read2st64_b32 v[214:215], v243 offset0:0 offset1:4
    s_waitcnt lgkmcnt(0)
    v_max3_u32 v220, v220, v221, v222
    v_max3_u32 v220, v220, v214, v215
    v_max_u32 v220, v220, v223
    v_cmp_eq_u32 vcc, -1, v220
    s_nop 4
    s_cbranch_vccnz p_vh2
    s_branch p_wh2
p_vh3:
    s_add_u32 s19, s19, 1
    s_cmp_ge_u32 s19, 32768
    s_cbranch_scc1 p_wh3
    s_mov_b32 s20, m0
    s_add_u32 m0, s17, 49152
    s_add_u32 s21, s16, 835584
    buffer_load_dwordx4 v204, s[12:15], s21 offen offset:0 sc1 lds
    buffer_load_dwordx4 v205, s[12:15], s21 offen offset:1024 sc1 lds
    buffer_load_dwordx4 v206, s[12:15], s21 offen offset:2048 sc1 lds
    buffer_load_dwordx4 v207, s[12:15], s21 offen offset:3072 sc1 lds
    s_mov_b32 m0, s20
    s_waitcnt vmcnt(0)
    ds_read2st64_b32 v[220:221], v241 offset0:192 offset1:196
    ds_read2st64_b32 v[222:223], v241 offset0:200 offset1:204
    s_waitcnt lgkmcnt(0)
    v_max3_u32 v220, v220, v221, v222
    v_max_u32 v220, v220, v223
    v_cmp_eq_u32 vcc, -1, v220
    s_nop 4
    s_cbranch_vccnz p_vh3
    s_branch p_wh3
p_vh4:
    s_add_u32 s19, s19, 1
    s_cmp_ge_u32 s19, 32768
    s_cbranch_scc1 p_wh4
    s_mov_b32 s20, m0
    s_add_u32 m0, s17, 65536
    s_add_u32 s21, s16, 1114112
    buffer_load_dwordx4 v204, s[12:15], s21 offen offset:0 sc1 lds
    buffer_load_dwordx4 v205, s[12:15], s21 offen offset:1024 sc1 lds
    buffer_load_dwordx4 v206, s[12:15], s21 offen offset:2048 sc1 lds
    buffer_load_dwordx4 v207, s[12:15], s21 offen offset:3072 sc1 lds
    s_mov_b32 m0, s20
    s_waitcnt vmcnt(0)
    ds_read2st64_b32 v[220:221], v242 offset0:0 offset1:4
    ds_read2st64_b32 v[222:223], v242 offset0:8 offset1:12
    s_waitcnt lgkmcnt(0)
    v_max3_u32 v220, v220, v221, v222
    v_max_u32 v220, v220, v223
    v_cmp_eq_u32 vcc, -1, v220
    s_nop 4
    s_cbranch_vccnz p_vh4
    s_branch p_wh4
p_vh5:
    s_add_u32 s19, s19, 1
    s_cmp_ge_u32 s19, 32768
    s_cbranch_scc1 p_wh5
    s_mov_b32 s20, m0
    s_add_u32 m0, s17, 81920
    s_add_u32 s21, s16, 1392640
    buffer_load_dwordx4 v204, s[12:15], s21 offen offset:0 sc1 lds
    buffer_load_dwordx4 v205, s[12:15], s21 offen offset:1024 sc1 lds
    buffer_load_dwordx4 v206, s[12:15], s21 offen offset:2048 sc1 lds
    buffer_load_dwordx4 v207, s[12:15], s21 offen offset:3072 sc1 lds
    s_mov_b32 m0, s20
    s_waitcnt vmcnt(0)
    ds_read2st64_b32 v[220:221], v242 offset0:64 offset1:68
    ds_read2st64_b32 v[222:223], v242 offset0:72 offset1:76
    s_waitcnt lgkmcnt(0)
    v_max3_u32 v220, v220, v221, v222
    v_max_u32 v220, v220, v223
    v_cmp_eq_u32 vcc, -1, v220
    s_nop 4
    s_cbranch_vccnz p_vh5
    s_branch p_wh5
p_vh6:
    s_add_u32 s19, s19, 1
    s_cmp_ge_u32 s19, 32768
    s_cbranch_scc1 p_wh6
    s_mov_b32 s20, m0
    s_add_u32 m0, s17, 98304
    s_add_u32 s21, s16, 1671168
    buffer_load_dwordx4 v204, s[12:15], s21 offen offset:0 sc1 lds
    buffer_load_dwordx4 v205, s[12:15], s21 offen offset:1024 sc1 lds
    buffer_load_dwordx4 v206, s[12:15], s21 offen offset:2048 sc1 lds
    buffer_load_dwordx4 v207, s[12:15], s21 offen offset:3072 sc1 lds
    s_mov_b32 m0, s20
    s_waitcnt vmcnt(0)
    ds_read2st64_b32 v[220:221], v242 offset0:128 offset1:132
    ds_read2st64_b32 v[222:223], v242 offset0:136 offset1:140
    s_waitcnt lgkmcnt(0)
    v_max3_u32 v220, v220, v221, v222
    v_max_u32 v220, v220, v223
    v_cmp_eq_u32 vcc, -1, v220
    s_nop 4
    s_cbranch_vccnz p_vh6
    s_branch p_wh6
p_vh7:
    s_add_u32 s19, s19, 1
    s_cmp_ge_u32 s19, 32768
    s_cbranch_scc1 p_wh7
    s_mov_b32 s20, m0
    s_add_u32 m0, s17, 114688
    s_add_u32 s21, s16, 1949696
    buffer_load_dwordx4 v204, s[12:15], s21 offen offset:0 sc1 lds
    buffer_load_dwordx4 v205, s[12:15], s21 offen offset:1024 sc1 lds
    buffer_load_dwordx4 v206, s[12:15], s21 offen offset:2048 sc1 lds
    buffer_load_dwordx4 v207, s[12:15], s21 offen offset:3072 sc1 lds
    s_mov_b32 m0, s20
    s_waitcnt vmcnt(0)
    ds_read2st64_b32 v[220:221], v242 offset0:192 offset1:196
    ds_read2st64_b32 v[222:223], v242 offset0:200 offset1:204
    s_waitcnt lgkmcnt(0)
    v_max3_u32 v220, v220, v221, v222
    v_max_u32 v220, v220, v223
    v_cmp_eq_u32 vcc, -1, v220
    s_nop 4
    s_cbranch_vccnz p_vh7
    s_branch p_wh7
p_end:
.section .rodata,"a"
.p2align 6
.amdhsa_kernel sequential_preLN__spectral_gfnet__glu_gated_glu__prompt_kernel
  .amdhsa_next_free_vgpr 512
  .amdhsa_next_free_sgpr 102
  .amdhsa_accum_offset 256
  .amdhsa_group_segment_fixed_size 0
  .amdhsa_kernarg_size 80
  .amdhsa_user_sgpr_count 2
  .amdhsa_user_sgpr_kernarg_segment_ptr 1
  .amdhsa_system_sgpr_workgroup_id_x 1
  .amdhsa_float_denorm_mode_32 3
  .amdhsa_float_denorm_mode_16_64 3
.end_amdhsa_kernel
```
